```python
import torch

def _softmax(x, axis=-1):
    return torch.softmax(x, dim=axis)
def _gelu(x):
    return torch.nn.functional.gelu(x, approximate="tanh")
def _silu(x):
    return torch.nn.functional.silu(x)
def _sigmoid(x):
    return torch.sigmoid(x)
def _layernorm(x, axis=-1, eps=1e-5):
    m = x.mean(dim=axis, keepdim=True)
    v = x.var(dim=axis, keepdim=True, unbiased=False)
    return (x - m) / torch.sqrt(v + eps)
def _scatter_add(tgt, idx, src, axis=0):
    return tgt.clone().index_add_(axis, idx, src)
def _segment_sum(src, seg, n):
    out = torch.zeros((n,) + src.shape[1:], dtype=src.dtype)
    return out.index_add_(0, seg, src)
def _pad(x, pw):
    flat = tuple(v for pair in reversed(pw) for v in pair)
    return torch.nn.functional.pad(x, flat)

kernel_name = 'parallel_sum__spectral_gfnet__dense_activation_silu__prompt'

def setup_inputs():

    _w = (lambda a: (lambda t: t.to(torch.bfloat16) if t.is_floating_point() else t)(torch.as_tensor(a)))
    def _A_setup():
        B, S, D = 1, 2048, 512
        Df = D // 2 + 1
        return {
            "x": _w((lambda *s: torch.randn(*s, dtype=torch.bfloat16) * 0.05)(B, S, D)),
            "w_r": _w((lambda *s: torch.randn(*s, dtype=torch.bfloat16) * 0.8)(S, Df) * 0.02),
            "w_i": _w((lambda *s: torch.randn(*s, dtype=torch.bfloat16) * 0.8)(S, Df) * 0.02),
        }
    _A_in = _A_setup()

    def _B_setup():
        B, S, D, F = 1, 2048, 512, 1792
        return {
            "x": _w((lambda *s: torch.randn(*s, dtype=torch.bfloat16) * 0.05)(B, S, D)),
            "w1": _w((lambda *s: torch.randn(*s, dtype=torch.bfloat16) * 0.8)(D, F) * (D ** -0.5)),
            "w2": _w((lambda *s: torch.randn(*s, dtype=torch.bfloat16) * 0.1)(F, D) * (F ** -0.5)),
        }
    _B_in = _B_setup()

    return {
        "A_x": _A_in["x"],
        "A_w_r": _A_in["w_r"],
        "A_w_i": _A_in["w_i"],
        "B_x": _B_in["x"],
        "B_w1": _B_in["w1"],
        "B_w2": _B_in["w2"],
    }

def reference(A_x, A_w_r, A_w_i, B_x, B_w1, B_w2):
    def _A_ref(x, w_r, w_i):
        B, S, D = x.shape
        X = (lambda x, axes=(-2,-1): torch.fft.rfft2(x.float(), dim=axes))(x, axes=(-2, -1))
        W = w_r + 1j * w_i
        X = X * W
        y = (lambda x, s, axes=(-2,-1): torch.fft.irfft2(x, s=s, dim=axes).to(torch.bfloat16))(X, (S, D), axes=(-2, -1))
        return y

    def _B_ref(x, w1, w2):
        h = torch.einsum("bsd,df->bsf", x, w1)
        h = _silu(h)
        out = torch.einsum("bsf,fd->bsd", h, w2)
        return out

    x = A_x
    xn = _layernorm(x, axis=-1)
    return x + _A_ref(xn, A_w_r, A_w_i) + _B_ref(xn, B_w1, B_w2)
```

```asm
; @launch grid=(256,1,1) block=(512,1,1) lds=163840
.amdgcn_target "amdgcn-amd-amdhsa--gfx950"
.text
.globl parallel_sum__spectral_gfnet__dense_activation_silu__prompt_kernel
.p2align 8
.type parallel_sum__spectral_gfnet__dense_activation_silu__prompt_kernel,@function
parallel_sum__spectral_gfnet__dense_activation_silu__prompt_kernel:
    s_cmp_ge_u32 s2, 256
    s_cbranch_scc1 K1_END
    s_load_dwordx4 s[24:27], s[0:1], 0
    s_load_dwordx4 s[28:31], s[0:1], 32
    s_load_dwordx2 s[22:23], s[0:1], 16
    s_load_dwordx2 s[90:91], s[0:1], 64
    s_getpc_b64 s[92:93]
    s_add_u32 s92, s92, parallel_sum__spectral_gfnet__dense_activation_silu__prompt_kernel@rel32@lo+4
    s_addc_u32 s93, s93, parallel_sum__spectral_gfnet__dense_activation_silu__prompt_kernel@rel32@hi+12
    s_mov_b32 s94, code_end-parallel_sum__spectral_gfnet__dense_activation_silu__prompt_kernel
    s_mov_b32 s95, 0x20000
    s_and_b32 s3, s2, 0xf8
    s_lshl_b32 s3, s3, 8
    v_lshlrev_b32 v8, 2, v0
    buffer_load_dword v8, v8, s[92:95], s3 offen
    v_lshrrev_b32 v2, 6, v0
    v_and_b32 v1, 63, v0
    v_readfirstlane_b32 s56, v2
    s_bfe_u32 s34, s2, 0x20001
    s_and_b32 s55, s2, 1
    s_lshr_b32 s36, s2, 5
    s_bfe_u32 s35, s2, 0x20003
    s_and_b32 s37, s56, 3
    s_lshl_b32 s51, s37, 12
    v_lshrrev_b32 v5, 5, v1
    s_cmp_lt_u32 s56, 4
    s_cbranch_scc1 K1_COMPUTE
    v_bfe_u32 v2, v1, 3, 2
    v_lshrrev_b32 v3, 4, v1
    v_and_b32 v4, 7, v1
    v_xor_b32 v4, v4, v3
    v_lshlrev_b32 v4, 4, v4
    s_lshl_b32 s58, s35, 1
    s_and_b32 s3, s34, 1
    s_add_u32 s58, s58, s3
    s_add_u32 s58, s58, s36
    s_and_b32 s58, s58, 7
    s_lshl_b32 s52, s58, 7
    s_mov_b32 s6, 2101248
    s_mov_b32 s7, 0x20000
    s_cmp_eq_u32 s36, 7
    s_cbranch_scc1 K1_LD
    v_lshl_add_u32 v2, v5, 4, v2
    v_lshl_add_u32 v2, v2, 10, v4
    v_add_u32 v20, 4096, v2
    v_xor_b32 v2, 64, v2
    v_add_u32 v21, 35840, v2
    s_lshl_b32 s3, s34, 7
    s_lshl_b32 s40, s37, 4
    s_add_u32 s3, s3, s40
    s_add_u32 s3, s3, s35
    s_lshl_b32 s48, s3, 12
    s_lshl_b32 s59, s37, 11
    s_add_u32 m0, s59, 81920
    s_add_u32 s52, s52, s48
    s_waitcnt lgkmcnt(0)
    s_sub_u32 s4, s24, 4096
    s_subb_u32 s5, s25, 0
    buffer_load_dwordx4 v20, s[4:7], s52 offen offset:0 lds
    buffer_load_dwordx4 v21, s[4:7], s52 offen offset:1024 lds
    s_add_u32 s88, s90, 22020096
    s_addc_u32 s89, s91, 0
    s_load_dword s66, s[88:89], 294912
    v_lshlrev_b32 v9, 4, v1
    s_mov_b64 s[8:9], s[28:29]
    s_mov_b32 s10, 1835008
    s_mov_b32 s11, 0x20000
    v_and_b32 v2, 15, v1
    v_lshlrev_b32 v4, 2, v3
    v_xor_b32 v2, v2, v4
    v_lshlrev_b32_e64 v2, 4, v2
    s_movk_i32 s3, 3584
    v_mad_u32_u24 v24, v3, s3, v2
    v_add_u32 v25, 13312, v24
    v_add_u32 v26, 26624, v24
    v_add_u32 v27, 39936, v24
    s_mul_i32 s57, s55, 7
    s_add_u32 s57, s57, s36
    s_lshl_b32 s3, s57, 8
    s_mul_i32 s49, s37, 57344
    s_add_u32 s49, s49, s3
    s_add_u32 s3, s58, 0
    s_and_b32 s3, s3, 7
    s_mul_i32 s3, s3, 229376
    s_add_u32 s53, s3, s49
    s_add_u32 m0, s51, 0
    s_nop 0
    buffer_load_dwordx4 v24, s[8:11], s53 offen offset:0 lds
    buffer_load_dwordx4 v25, s[8:11], s53 offen offset:1024 lds
    buffer_load_dwordx4 v26, s[8:11], s53 offen offset:2048 lds
    buffer_load_dwordx4 v27, s[8:11], s53 offen offset:3072 lds
    s_add_u32 s3, s58, 1
    s_and_b32 s3, s3, 7
    s_lshl_b32 s3, s3, 7
    s_add_u32 s52, s3, s48
    s_add_u32 m0, s59, 98304
    s_nop 0
    buffer_load_dwordx4 v20, s[4:7], s52 offen offset:0 lds
    buffer_load_dwordx4 v21, s[4:7], s52 offen offset:1024 lds
    s_add_u32 s3, s58, 1
    s_and_b32 s3, s3, 7
    s_mul_i32 s3, s3, 229376
    s_add_u32 s53, s3, s49
    s_add_u32 m0, s51, 16384
    s_nop 0
    buffer_load_dwordx4 v24, s[8:11], s53 offen offset:0 lds
    buffer_load_dwordx4 v25, s[8:11], s53 offen offset:1024 lds
    buffer_load_dwordx4 v26, s[8:11], s53 offen offset:2048 lds
    buffer_load_dwordx4 v27, s[8:11], s53 offen offset:3072 lds
    s_add_u32 s3, s58, 2
    s_and_b32 s3, s3, 7
    s_lshl_b32 s3, s3, 7
    s_add_u32 s52, s3, s48
    s_add_u32 m0, s59, 106496
    s_nop 0
    buffer_load_dwordx4 v20, s[4:7], s52 offen offset:0 lds
    buffer_load_dwordx4 v21, s[4:7], s52 offen offset:1024 lds
    s_add_u32 s3, s58, 2
    s_and_b32 s3, s3, 7
    s_mul_i32 s3, s3, 229376
    s_add_u32 s53, s3, s49
    s_add_u32 m0, s51, 32768
    s_nop 0
    buffer_load_dwordx4 v24, s[8:11], s53 offen offset:0 lds
    buffer_load_dwordx4 v25, s[8:11], s53 offen offset:1024 lds
    buffer_load_dwordx4 v26, s[8:11], s53 offen offset:2048 lds
    buffer_load_dwordx4 v27, s[8:11], s53 offen offset:3072 lds
    s_waitcnt vmcnt(12) lgkmcnt(0)
    s_barrier
    s_mov_b64 s[12:13], s[90:91]
    s_mov_b32 s14, 22872064
    s_mov_b32 s15, 0x20000
    s_add_u32 s66, s66, 1
    s_or_b32 s66, s66, 1
    v_mov_b32 v68, 0
    v_mov_b32 v2, 158464
    ds_write_b32 v2, v68
    ds_write_b32 v2, v68 offset:4
    s_lshl_b32 s3, s2, 2
    s_add_u32 s3, s3, s37
    s_lshl_b32 s3, s3, 7
    s_add_u32 s3, s3, 22609920
    s_lshl_b32 s40, s37, 8
    s_add_u32 s40, s40, s2
    s_lshl_b32 s40, s40, 7
    s_add_u32 s40, s40, 22740992
    v_and_b32 v2, 31, v1
    v_mov_b32 v3, s3
    v_mov_b32 v4, s40
    v_cmp_gt_u32 vcc, 32, v1
    s_nop 1
    v_cndmask_b32 v3, v4, v3, vcc
    v_lshl_add_u32 v3, v2, 2, v3
    buffer_store_dword v68, v3, s[12:15], 0 offen sc1
    s_add_u32 s3, s58, 3
    s_and_b32 s3, s3, 7
    s_lshl_b32 s3, s3, 7
    s_add_u32 s52, s3, s48
    s_add_u32 m0, s59, 114688
    s_nop 0
    buffer_load_dwordx4 v20, s[4:7], s52 offen offset:0 lds
    buffer_load_dwordx4 v21, s[4:7], s52 offen offset:1024 lds
    s_add_u32 s3, s58, 3
    s_and_b32 s3, s3, 7
    s_mul_i32 s3, s3, 229376
    s_add_u32 s53, s3, s49
    s_add_u32 m0, s51, 49152
    s_nop 0
    buffer_load_dwordx4 v24, s[8:11], s53 offen offset:0 lds
    buffer_load_dwordx4 v25, s[8:11], s53 offen offset:1024 lds
    buffer_load_dwordx4 v26, s[8:11], s53 offen offset:2048 lds
    buffer_load_dwordx4 v27, s[8:11], s53 offen offset:3072 lds
    s_waitcnt vmcnt(13) lgkmcnt(0)
    s_barrier
    s_add_u32 s3, s58, 4
    s_and_b32 s3, s3, 7
    s_lshl_b32 s3, s3, 7
    s_add_u32 s52, s3, s48
    s_add_u32 m0, s59, 131072
    s_nop 0
    buffer_load_dwordx4 v20, s[4:7], s52 offen offset:0 lds
    buffer_load_dwordx4 v21, s[4:7], s52 offen offset:1024 lds
    s_add_u32 s3, s58, 4
    s_and_b32 s3, s3, 7
    s_mul_i32 s3, s3, 229376
    s_add_u32 s53, s3, s49
    s_add_u32 m0, s51, 65536
    s_nop 0
    buffer_load_dwordx4 v24, s[8:11], s53 offen offset:0 lds
    buffer_load_dwordx4 v25, s[8:11], s53 offen offset:1024 lds
    buffer_load_dwordx4 v26, s[8:11], s53 offen offset:2048 lds
    buffer_load_dwordx4 v27, s[8:11], s53 offen offset:3072 lds
    s_mov_b64 s[16:17], s[26:27]
    s_mov_b32 s18, 1052672
    s_mov_b32 s19, 0x20000
    s_mov_b64 s[44:45], s[22:23]
    s_mov_b64 s[20:21], s[44:45]
    s_mov_b32 s22, 1052672
    s_mov_b32 s23, 0x20000
    s_and_b32 s84, s2, 3
    s_lshl_b32 s45, s84, 7
    s_add_u32 s45, s45, 2
    v_and_b32_e64 v2, 31, v1
    v_lshl_add_u32 v3, v2, 2, s45
    s_movk_i32 s45, 514
    v_mad_u32_u24 v44, v5, s45, v3
    s_bfe_u32 s45, s2, 0x30002
    s_lshl_b32 s63, s45, 2
    s_add_u32 s63, s63, s37
    s_lshl_b32 s63, s63, 1
    s_lshl_b32 s44, s36, 8
    s_add_u32 s63, s63, s44
    s_mul_i32 s44, s63, 514
    s_add_u32 s45, s44, 32896
    s_add_u32 s46, s44, 65792
    s_add_u32 s47, s44, 98688
    buffer_load_dword v28, v44, s[16:19], s44 offen
    buffer_load_dword v32, v44, s[20:23], s44 offen
    buffer_load_dword v29, v44, s[16:19], s45 offen
    buffer_load_dword v33, v44, s[20:23], s45 offen
    s_waitcnt vmcnt(17)
    s_barrier
    v_and_b32 v2, 15, v1
    v_cmp_gt_u32 vcc, 16, v1
    s_lshl_b32 s3, s37, 7
    s_add_u32 s3, s3, 157952
    v_mov_b32 v3, s3
    v_mov_b32 v4, 157696
    v_cndmask_b32 v3, v4, v3, vcc
    v_lshl_add_u32 v3, v2, 3, v3
    ds_read_b64 v[62:63], v3
    s_lshl_b32 s3, s34, 2
    s_add_u32 s3, s3, s35
    s_lshl_b32 s3, s3, 1
    s_add_u32 s3, s3, s55
    s_lshl_b32 s3, s3, 3
    s_add_u32 s3, s3, s36
    s_lshl_b32 s3, s3, 7
    s_add_u32 s3, s3, 22282240
    v_mov_b32 v4, s3
    s_lshl_b32 s3, s57, 3
    s_add_u32 s3, s3, s58
    s_lshl_b32 s3, s3, 2
    s_add_u32 s3, s3, s37
    s_lshl_b32 s3, s3, 8
    s_add_u32 s3, s3, 22020096
    v_mov_b32 v3, s3
    v_cndmask_b32 v4, v4, v3, vcc
    v_lshl_add_u32 v69, v2, 4, v4
    v_mov_b32 v64, s66
    v_mov_b32 v65, s66
    s_cmp_eq_u32 s37, 0
    s_cselect_b32 s40, 0xff0000, 0
    s_mov_b32 s41, 0
    s_or_b32 s40, s40, 0xffff
    s_mov_b64 exec, s[40:41]
    s_waitcnt lgkmcnt(0)
    buffer_store_dwordx4 v[62:65], v69, s[12:15], 0 offen sc1
    s_mov_b64 exec, -1
    s_add_u32 s3, s58, 5
    s_and_b32 s3, s3, 7
    s_lshl_b32 s3, s3, 7
    s_add_u32 s52, s3, s48
    s_add_u32 m0, s59, 139264
    s_nop 0
    buffer_load_dwordx4 v20, s[4:7], s52 offen offset:0 lds
    buffer_load_dwordx4 v21, s[4:7], s52 offen offset:1024 lds
    s_add_u32 s3, s58, 5
    s_and_b32 s3, s3, 7
    s_mul_i32 s3, s3, 229376
    s_add_u32 s53, s3, s49
    s_add_u32 m0, s51, 81920
    s_nop 0
    buffer_load_dwordx4 v24, s[8:11], s53 offen offset:0 lds
    buffer_load_dwordx4 v25, s[8:11], s53 offen offset:1024 lds
    buffer_load_dwordx4 v26, s[8:11], s53 offen offset:2048 lds
    buffer_load_dwordx4 v27, s[8:11], s53 offen offset:3072 lds
    buffer_load_dword v30, v44, s[16:19], s46 offen
    buffer_load_dword v34, v44, s[20:23], s46 offen
    buffer_load_dword v31, v44, s[16:19], s47 offen
    buffer_load_dword v35, v44, s[20:23], s47 offen
    s_waitcnt vmcnt(21)
    s_barrier
    s_add_u32 s3, s58, 6
    s_and_b32 s3, s3, 7
    s_lshl_b32 s3, s3, 7
    s_add_u32 s52, s3, s48
    s_add_u32 m0, s59, 147456
    s_nop 0
    buffer_load_dwordx4 v20, s[4:7], s52 offen offset:0 lds
    buffer_load_dwordx4 v21, s[4:7], s52 offen offset:1024 lds
    s_add_u32 s3, s58, 6
    s_and_b32 s3, s3, 7
    s_mul_i32 s3, s3, 229376
    s_add_u32 s53, s3, s49
    s_add_u32 m0, s51, 98304
    s_nop 0
    buffer_load_dwordx4 v24, s[8:11], s53 offen offset:0 lds
    buffer_load_dwordx4 v25, s[8:11], s53 offen offset:1024 lds
    buffer_load_dwordx4 v26, s[8:11], s53 offen offset:2048 lds
    buffer_load_dwordx4 v27, s[8:11], s53 offen offset:3072 lds
    s_mov_b64 s[92:93], s[30:31]
    s_mov_b32 s94, 1835008
    s_mov_b32 s95, 0x20000
    s_lshl_b32 s3, s2, 2
    s_add_u32 s3, s3, s37
    s_mul_i32 s54, s3, 1792
    buffer_load_dwordx4 v[46:49], v9, s[92:95], s54 offen offset:0
    s_waitcnt vmcnt(22)
    s_barrier
    s_add_u32 s3, s58, 7
    s_and_b32 s3, s3, 7
    s_mul_i32 s3, s3, 229376
    s_add_u32 s53, s3, s49
    s_add_u32 m0, s51, 114688
    s_nop 0
    buffer_load_dwordx4 v24, s[8:11], s53 offen offset:0 lds
    buffer_load_dwordx4 v25, s[8:11], s53 offen offset:1024 lds
    buffer_load_dwordx4 v26, s[8:11], s53 offen offset:2048 lds
    buffer_load_dwordx4 v27, s[8:11], s53 offen offset:3072 lds
    buffer_load_dwordx4 v[46:49], v9, s[92:95], s54 offen offset:1024
    s_waitcnt vmcnt(16)
    s_barrier
    s_add_u32 s3, s58, 7
    s_and_b32 s3, s3, 7
    s_lshl_b32 s3, s3, 7
    s_add_u32 s52, s3, s48
    s_add_u32 m0, s59, 131072
    s_nop 0
    buffer_load_dwordx4 v20, s[4:7], s52 offen offset:0 lds
    buffer_load_dwordx4 v21, s[4:7], s52 offen offset:1024 lds
    s_add_u32 s48, s48, 262144
    s_waitcnt vmcnt(8)
    s_barrier
    v_bfe_u32 v2, v1, 3, 2
    v_bfe_u32 v3, v1, 2, 1
    v_and_b32 v4, 3, v1
    v_lshl_add_u32 v2, v2, 1, v3
    v_lshl_add_u32 v66, v2, 4, v4
    s_lshl_b32 s3, s37, 7
    s_lshl_b32 s40, s35, 2
    v_lshrrev_b32 v2, 4, v1
    v_and_b32 v3, 15, v1
    v_lshlrev_b32_e64 v3, 4, v3
    v_lshl_add_u32 v69, v2, 10, v3
    s_lshl_b32 s32, s57, 5
    s_add_u32 s32, s32, s37
    s_lshl_b32 s32, s32, 8
    s_add_u32 s32, s32, 22020096
    s_add_u32 s33, s32, 4096
    s_add_u32 s3, s3, s40
    s_lshl_b32 s40, s34, 9
    s_add_u32 s3, s3, s40
    v_add_u32 v66, s3, v66
    v_lshlrev_b32 v67, 4, v66
    s_mov_b32 s62, 22282240
    buffer_load_dwordx4 v[50:53], v67, s[12:15], s62 offen sc1
    buffer_load_dwordx4 v[54:57], v69, s[12:15], s32 offen sc1
    buffer_load_dwordx4 v[58:61], v69, s[12:15], s33 offen sc1
    s_add_u32 s3, s58, 0
    s_and_b32 s3, s3, 7
    s_lshl_b32 s3, s3, 7
    s_add_u32 s52, s3, s48
    s_add_u32 m0, s59, 139264
    s_nop 0
    buffer_load_dwordx4 v20, s[4:7], s52 offen offset:0 lds
    buffer_load_dwordx4 v21, s[4:7], s52 offen offset:1024 lds
    s_waitcnt vmcnt(5)
    s_barrier
    s_add_u32 s3, s58, 1
    s_and_b32 s3, s3, 7
    s_lshl_b32 s3, s3, 7
    s_add_u32 s52, s3, s48
    s_add_u32 m0, s59, 147456
    s_nop 0
    buffer_load_dwordx4 v20, s[4:7], s52 offen offset:0 lds
    buffer_load_dwordx4 v21, s[4:7], s52 offen offset:1024 lds
    s_waitcnt vmcnt(2)
    s_barrier
    s_add_u32 s3, s58, 2
    s_and_b32 s3, s3, 7
    s_lshl_b32 s3, s3, 7
    s_add_u32 s52, s3, s48
    s_add_u32 m0, s59, 131072
    s_nop 0
    buffer_load_dwordx4 v20, s[4:7], s52 offen offset:0 lds
    buffer_load_dwordx4 v21, s[4:7], s52 offen offset:1024 lds
    s_mov_b32 s61, 0
    v_xor_b32 v2, s66, v61
K1_CHECKF:
    v_xor_b32 v3, s66, v52
    v_or_b32 v2, v2, v3
    v_xor_b32 v3, s66, v53
    v_or_b32 v2, v2, v3
    v_xor_b32 v3, s66, v56
    v_or_b32 v2, v2, v3
    v_xor_b32 v3, s66, v57
    v_or_b32 v2, v2, v3
    v_xor_b32 v3, s66, v60
    v_or_b32 v2, v2, v3
    v_cmp_ne_u32 vcc, 0, v2
    s_cbranch_vccz K1_GOTF
    s_add_u32 s61, s61, 1
    s_cmp_gt_u32 s61, 4000
    s_cbranch_scc1 K1_FALLBACKF
    s_sleep 4
    buffer_load_dwordx4 v[50:53], v67, s[12:15], s62 offen sc1
    buffer_load_dwordx4 v[54:57], v69, s[12:15], s32 offen sc1
    buffer_load_dwordx4 v[58:61], v69, s[12:15], s33 offen sc1
    s_waitcnt vmcnt(0)
    v_xor_b32 v2, s66, v61
    s_branch K1_CHECKF
K1_FALLBACKF:
    v_lshl_add_u32 v67, v66, 10, 0
    v_add_u32 v67, 4096, v67
    v_mov_b32 v2, 0
    v_mov_b32 v3, 0
    v_mov_b32 v4, 0x3f803f80
    s_mov_b32 s61, 0
K1_FBLOOPF:
    buffer_load_dwordx4 v[50:53], v67, s[4:7], s61 offen
    s_waitcnt vmcnt(0)
    v_dot2_f32_bf16 v2, v50, v50, v2
    v_dot2_f32_bf16 v3, v50, v4, v3
    s_nop 2
    v_dot2_f32_bf16 v2, v51, v51, v2
    v_dot2_f32_bf16 v3, v51, v4, v3
    s_nop 2
    v_dot2_f32_bf16 v2, v52, v52, v2
    v_dot2_f32_bf16 v3, v52, v4, v3
    s_nop 2
    v_dot2_f32_bf16 v2, v53, v53, v2
    v_dot2_f32_bf16 v3, v53, v4, v3
    s_nop 2
    s_add_u32 s61, s61, 16
    s_cmp_lt_u32 s61, 1024
    s_cbranch_scc1 K1_FBLOOPF
    s_nop 4
    v_mov_b32 v7, 0x3b000000
    v_mul_f32 v3, v7, v3
    v_mul_f32 v6, v3, v3
    v_fma_f32 v2, v2, v7, -v6
    v_max_f32 v2, 0, v2
    v_add_f32 v2, 0x3727c5ac, v2
    v_rsq_f32 v2, v2
    s_nop 1
    v_mov_b32 v50, v2
    v_mov_b32 v51, v3
    v_and_b32 v2, 9, v1
    v_bfe_u32 v3, v1, 1, 1
    v_lshl_or_b32 v2, v3, 2, v2
    v_bfe_u32 v3, v1, 2, 1
    v_lshl_or_b32 v2, v3, 1, v2
    v_lshlrev_b32 v2, 2, v2
    v_lshrrev_b32 v3, 4, v1
    s_mov_b32 s3, 458752
    v_mad_u32_u24 v2, v3, s3, v2
    s_lshl_b32 s61, s57, 2
    s_add_u32 s61, s61, s37
    s_lshl_b32 s61, s61, 6
    s_mov_b32 s3, 0
    v_mov_b32 v54, 0
    v_mov_b32 v55, 0
    v_mov_b32 v58, 0
    v_mov_b32 v59, 0
K1_FBLOOPC:
    buffer_load_dword v3, v2, s[8:11], s61 offen
    s_waitcnt vmcnt(0)
    v_lshlrev_b32 v4, 16, v3
    v_and_b32 v3, 0xffff0000, v3
    v_add_f32 v54, v54, v4
    v_add_f32 v55, v55, v3
    s_add_u32 s61, s61, 3584
    s_add_u32 s3, s3, 1
    s_cmp_lt_u32 s3, 128
    s_cbranch_scc1 K1_FBLOOPC
K1_GOTF:
    v_and_b32 v2, 31, v1
    v_add_f32 v54, v54, v58
    v_add_f32 v55, v55, v59
    s_lshl_b32 s3, s37, 8
    s_add_u32 s3, s3, 155648
    v_lshl_add_u32 v2, v2, 3, s3
    v_mov_b32 v56, v54
    v_mov_b32 v57, v55
    v_mul_f32 v50, 0xbfb8aa3b, v50
    v_mul_f32 v51, v51, v50
    v_permlane32_swap_b32 v54, v56
    v_permlane32_swap_b32 v55, v57
    v_sub_f32 v51, 0, v51
    v_add_f32 v54, v54, v56
    v_add_f32 v55, v55, v57
    ds_write_b64 v2, v[50:51]
    v_mov_b32 v56, v54
    v_mov_b32 v57, v55
    v_and_b32 v3, 15, v1
    s_lshl_b32 s3, s37, 7
    v_permlane16_swap_b32 v54, v56
    v_permlane16_swap_b32 v55, v57
    s_add_u32 s3, s3, 156672
    v_lshl_add_u32 v3, v3, 3, s3
    v_add_f32 v54, v54, v56
    v_add_f32 v55, v55, v57
    ds_write_b64 v3, v[54:55]
    s_waitcnt vmcnt(2) lgkmcnt(0)
    s_barrier
    s_add_u32 s3, s58, 3
    s_and_b32 s3, s3, 7
    s_lshl_b32 s3, s3, 7
    s_add_u32 s52, s3, s48
    s_add_u32 m0, s59, 0
    s_nop 0
    buffer_load_dwordx4 v20, s[4:7], s52 offen offset:0 lds
    buffer_load_dwordx4 v21, s[4:7], s52 offen offset:1024 lds
    s_add_u32 s3, s58, 4
    s_and_b32 s3, s3, 7
    s_lshl_b32 s3, s3, 7
    s_add_u32 s52, s3, s48
    s_add_u32 m0, s59, 8192
    s_nop 0
    buffer_load_dwordx4 v20, s[4:7], s52 offen offset:0 lds
    buffer_load_dwordx4 v21, s[4:7], s52 offen offset:1024 lds
    s_waitcnt vmcnt(4)
    s_barrier
    s_add_u32 s3, s58, 5
    s_and_b32 s3, s3, 7
    s_lshl_b32 s3, s3, 7
    s_add_u32 s52, s3, s48
    s_add_u32 m0, s59, 16384
    s_nop 0
    buffer_load_dwordx4 v20, s[4:7], s52 offen offset:0 lds
    buffer_load_dwordx4 v21, s[4:7], s52 offen offset:1024 lds
    s_add_u32 s3, s58, 6
    s_and_b32 s3, s3, 7
    s_lshl_b32 s3, s3, 7
    s_add_u32 s52, s3, s48
    s_add_u32 m0, s59, 24576
    s_nop 0
    buffer_load_dwordx4 v20, s[4:7], s52 offen offset:0 lds
    buffer_load_dwordx4 v21, s[4:7], s52 offen offset:1024 lds
    s_waitcnt vmcnt(6)
    s_barrier
    s_add_u32 s3, s58, 7
    s_and_b32 s3, s3, 7
    s_lshl_b32 s3, s3, 7
    s_add_u32 s52, s3, s48
    s_add_u32 m0, s59, 32768
    s_nop 0
    buffer_load_dwordx4 v20, s[4:7], s52 offen offset:0 lds
    buffer_load_dwordx4 v21, s[4:7], s52 offen offset:1024 lds
    s_mov_b32 s86, 0x05040100
    s_mov_b32 s87, 0x07060302
    s_lshl_b32 s3, s37, 1
    v_and_b32 v2, 7, v1
    v_xor_b32 v2, v2, v5
    v_xor_b32 v2, s3, v2
    v_and_b32 v3, 31, v1
    v_lshlrev_b32 v3, 8, v3
    v_lshl_add_u32 v44, v2, 4, v3
    v_perm_b32 v36, v32, v28, s86
    v_perm_b32 v37, v33, v29, s86
    v_perm_b32 v38, v34, v30, s86
    v_perm_b32 v39, v35, v31, s86
    ds_write_b128 v44, v[36:39] offset:40960
    v_perm_b32 v40, v32, v28, s87
    v_perm_b32 v41, v33, v29, s87
    v_perm_b32 v42, v34, v30, s87
    v_perm_b32 v43, v35, v31, s87
    ds_write_b128 v44, v[40:43] offset:41088
    s_waitcnt vmcnt(6) lgkmcnt(0)
    s_barrier
    s_lshl_b32 s84, s84, 2
    s_add_u32 s84, s84, s37
    s_lshl_b32 s84, s84, 17
    s_lshl_b32 s63, s35, 11
    s_add_u32 s84, s84, s63
    s_lshr_b32 s63, s2, 7
    s_lshl_b32 s63, s63, 10
    s_add_u32 s84, s84, s63
    s_bfe_u32 s63, s2, 0x20005
    s_lshl_b32 s63, s63, 8
    s_add_u32 s84, s84, s63
    s_bfe_u32 s63, s2, 0x10002
    s_lshl_b32 s63, s63, 7
    s_add_u32 s84, s84, s63
    s_add_u32 s84, s84, 9437184
    s_add_u32 s85, s84, 65536
    v_lshrrev_b32 v3, 4, v1
    v_and_b32 v2, 7, v1
    v_xor_b32 v3, v3, v2
    v_lshrrev_b32 v4, 3, v1
    s_lshl_b32 s3, s37, 11
    v_lshl_add_u32 v44, v4, 7, s3
    v_lshl_add_u32 v44, v3, 4, v44
    v_xor_b32 v3, 64, v44
    ds_read_b128 v[28:31], v44 offset:40960
    ds_read_b128 v[32:35], v3 offset:41984
    v_lshlrev_b32 v2, 4, v2
    v_lshl_add_u32 v45, v4, 13, v2
    s_waitcnt lgkmcnt(1)
    buffer_store_dwordx4 v[28:31], v45, s[12:15], s84 offen sc1
    s_waitcnt lgkmcnt(0)
    buffer_store_dwordx4 v[32:35], v45, s[12:15], s85 offen sc1
    s_waitcnt vmcnt(2)
    s_barrier
    v_mov_b32 v66, 158464
    s_cmp_lg_u32 s37, 1
    s_cbranch_scc1 K1_F1A
    s_lshl_b32 s3, s2, 7
    s_add_u32 s3, s3, 22773760
    v_lshlrev_b32 v2, 2, v1
    v_mov_b32_e64 v4, s66
    s_mov_b64 exec, 0xffffffff
    buffer_store_dword v4, v2, s[12:15], s3 offen sc1
    s_mov_b64 exec, -1
K1_F1A:
    s_bfe_u32 s32, s2, 0x20001
    s_and_b32 s3, s2, 1
    s_lshl_b32 s3, s3, 3
    s_lshr_b32 s33, s2, 5
    s_add_u32 s33, s33, s3
    s_bfe_u32 s64, s2, 0x20003
    s_lshl_b32 s65, s33, 2
    s_add_u32 s65, s65, s32
    s_mov_b64 s[16:17], s[30:31]
    s_mov_b32 s18, 1835008
    s_mov_b32 s19, 0x20000
    s_mul_i32 s3, s32, 448
    s_lshl_b32 s40, s37, 4
    s_add_u32 s3, s3, s40
    s_lshl_b32 s3, s3, 3
    s_add_u32 s3, s3, s64
    s_lshl_b32 s61, s3, 7
    s_lshl_b32 s3, s64, 1
    s_lshr_b32 s40, s2, 5
    s_add_u32 s3, s3, s40
    s_mul_i32 s3, s3, 0
    s_cmp_ge_u32 s3, 7
    s_cselect_b32 s40, 7, 0
    s_sub_u32 s50, s3, s40
    s_lshl_b32 s3, s50, 16
    s_add_u32 s61, s61, s3
    v_lshrrev_b32 v3, 4, v1
    v_and_b32 v2, 15, v1
    v_lshlrev_b32 v4, 2, v3
    v_xor_b32 v2, v2, v4
    v_lshrrev_b32 v4, 3, v2
    v_and_b32 v2, 7, v2
    v_lshlrev_b32 v2, 4, v2
    v_lshl_add_u32 v2, v4, 9, v2
    v_lshl_add_u32 v10, v3, 10, v2
    v_add_u32 v11, 3072, v10
    v_add_u32 v12, 6144, v10
    v_add_u32 v13, 9216, v10
    s_add_u32 m0, s51, 49152
    s_nop 0
    buffer_load_dwordx4 v10, s[16:19], s61 offen offset:0 lds
    buffer_load_dwordx4 v11, s[16:19], s61 offen offset:1024 lds
    buffer_load_dwordx4 v12, s[16:19], s61 offen offset:2048 lds
    buffer_load_dwordx4 v13, s[16:19], s61 offen offset:3072 lds
    s_add_u32 s61, s61, 65536
    s_add_u32 m0, s51, 65536
    s_nop 0
    buffer_load_dwordx4 v10, s[16:19], s61 offen offset:0 lds
    buffer_load_dwordx4 v11, s[16:19], s61 offen offset:1024 lds
    buffer_load_dwordx4 v12, s[16:19], s61 offen offset:2048 lds
    buffer_load_dwordx4 v13, s[16:19], s61 offen offset:3072 lds
    s_add_u32 s61, s61, 65536
    s_waitcnt vmcnt(8)
    s_lshl_b32 s3, s2, 2
    s_add_u32 s3, s3, s37
    s_lshl_b32 s3, s3, 7
    s_add_u32 s3, s3, 22609920
    v_lshlrev_b32 v2, 2, v1
    v_mov_b32 v4, s66
    s_mov_b64 exec, 0xffffffff
    buffer_store_dword v4, v2, s[12:15], s3 offen sc1
    s_mov_b64 exec, -1
    s_mov_b32 s67, 0
K1_CNT1_0:
    s_sleep 1
    ds_read_b32 v67, v66 offset:0
    s_add_u32 s67, s67, 1
    s_cmp_gt_u32 s67, 100000
    s_cbranch_scc1 K1_CNTE1_0
    s_waitcnt lgkmcnt(0)
    v_readfirstlane_b32 s3, v67
    s_nop 0
    s_cmp_lt_u32 s3, 4
    s_cbranch_scc1 K1_CNT1_0
K1_CNTE1_0:
    s_add_u32 m0, s51, 81920
    s_nop 0
    buffer_load_dwordx4 v10, s[16:19], s61 offen offset:0 lds
    buffer_load_dwordx4 v11, s[16:19], s61 offen offset:1024 lds
    buffer_load_dwordx4 v12, s[16:19], s61 offen offset:2048 lds
    buffer_load_dwordx4 v13, s[16:19], s61 offen offset:3072 lds
    s_add_u32 s61, s61, 65536
    s_and_b32 s3, s33, 3
    s_lshl_b32 s3, s3, 3
    s_lshr_b32 s43, s33, 2
    s_lshl_b32 s43, s43, 1
    s_add_u32 s3, s3, s43
    s_lshr_b32 s43, s32, 1
    s_add_u32 s3, s3, s43
    s_and_b32 s43, s32, 1
    s_mul_i32 s43, s43, 96
    s_add_u32 s3, s3, s43
    s_lshl_b32 s3, s3, 7
    s_add_u32 s3, s3, 22773760
    v_and_b32 v2, 3, v1
    v_lshl_add_u32 v18, v2, 12, s3
    s_mov_b64 exec, 15
    buffer_load_dword v15, v18, s[12:15], 0 offen sc1
    s_mov_b64 exec, -1
    s_lshl_b32 s3, s33, 2
    s_lshr_b32 s43, s37, 1
    s_add_u32 s3, s3, s43
    s_mul_i32 s3, s3, 112
    s_mul_i32 s43, s32, 28
    s_add_u32 s3, s3, s43
    s_and_b32 s43, s37, 1
    s_lshl_b32 s43, s43, 1
    s_add_u32 s3, s3, s43
    s_lshl_b32 s43, s50, 2
    s_add_u32 s3, s3, s43
    s_lshl_b32 s60, s3, 10
    s_lshl_b32 s44, s37, 11
    s_lshl_b32 s43, s2, 13
    s_add_u32 s43, s43, s44
    s_add_u32 s47, s43, 7340032
    s_add_u32 s48, s43, 9437184
    s_lshr_b32 s3, s2, 4
    s_lshl_b32 s43, s37, 5
    s_add_u32 s3, s3, s43
    s_lshl_b32 s3, s3, 7
    s_add_u32 s3, s3, 22609920
    v_and_b32_e64 v2, 1, v1
    v_lshl_add_u32 v14, v2, 11, s3
    v_bfe_u32 v2, v1, 1, 3
    v_lshl_add_u32 v14, v2, 14, v14
    s_add_u32 s3, s2, 1
    s_and_b32 s3, s3, 127
    s_sub_u32 s43, 128, s3
    s_min_u32 s3, s3, s43
    s_sub_u32 s3, s3, 1
    s_bfe_u32 s3, s3, 0x10005
    s_and_b32 s43, s37, 1
    s_lshl_b32 s43, s43, 4
    s_add_u32 s3, s3, s43
    s_add_u32 s3, s3, 224
    s_lshl_b32 s3, s3, 7
    s_add_u32 s3, s3, 22839296
    v_and_b32 v2, 7, v1
    v_lshl_add_u32 v16, v2, 8, s3
    v_cmp_gt_u32 vcc, 16, v1
    s_nop 1
    v_cndmask_b32 v14, v16, v14, vcc
    s_mov_b64 exec, 15
    s_waitcnt vmcnt(0)
    v_cmp_ne_u32 vcc, s66, v15
    s_cbranch_vccz P2_FAF_END0
    s_mov_b32 s67, 0
P2_FAF_SPIN0:
    s_mov_b64 exec, vcc
    s_sleep 4
    buffer_load_dword v15, v18, s[12:15], 0 offen sc1
    s_add_u32 s67, s67, 1
    s_cmp_gt_u32 s67, 20000
    s_waitcnt vmcnt(0)
    s_cbranch_scc1 P2_FAF_END0
    v_cmp_ne_u32 vcc, s66, v15
    s_cbranch_vccnz P2_FAF_SPIN0
P2_FAF_END0:
    s_mov_b64 exec, -1
    s_mov_b32 s67, 0
K1_CNT3_0:
    s_sleep 1
    ds_read_b32 v67, v66 offset:0
    s_add_u32 s67, s67, 1
    s_cmp_gt_u32 s67, 100000
    s_cbranch_scc1 K1_CNTE3_0
    s_waitcnt lgkmcnt(0)
    v_readfirstlane_b32 s3, v67
    s_nop 0
    s_cmp_lt_u32 s3, 12
    s_cbranch_scc1 K1_CNT3_0
K1_CNTE3_0:
    s_branch P2_LOADER
K1_LD:
    v_lshl_add_u32 v2, v5, 3, v2
    v_lshl_add_u32 v2, v2, 15, v4
    v_add_u32 v20, 4096, v2
    v_add_u32 v22, 6144, v2
    v_xor_b32 v2, 64, v2
    v_add_u32 v21, 134144, v2
    v_add_u32 v23, 136192, v2
    s_lshl_b32 s3, s34, 6
    s_add_u32 s3, s3, s35
    s_lshl_b32 s3, s3, 3
    s_add_u32 s3, s3, s37
    s_lshl_b32 s48, s3, 10
    s_lshl_b32 s59, s37, 11
    s_mov_b32 m0, s51
    s_add_u32 s52, s52, s48
    s_waitcnt lgkmcnt(0)
    s_sub_u32 s4, s24, 4096
    s_subb_u32 s5, s25, 0
    buffer_load_dwordx4 v20, s[4:7], s52 offen offset:0 lds
    buffer_load_dwordx4 v21, s[4:7], s52 offen offset:1024 lds
    buffer_load_dwordx4 v22, s[4:7], s52 offen offset:2048 lds
    buffer_load_dwordx4 v23, s[4:7], s52 offen offset:3072 lds
    s_add_u32 s88, s90, 22020096
    s_addc_u32 s89, s91, 0
    s_load_dword s66, s[88:89], 294912
    v_lshlrev_b32 v9, 4, v1
    s_getpc_b64 s[8:9]
    s_add_u32 s8, s8, dft_table@rel32@lo+4
    s_addc_u32 s9, s9, dft_table@rel32@hi+12
    s_mov_b32 s10, 0x20000
    s_mov_b32 s11, 0x20000
    s_lshl_b32 s3, s55, 16
    s_add_u32 s49, s3, s59
    s_add_u32 s3, s58, 0
    s_and_b32 s3, s3, 7
    s_mul_i32 s3, s3, 8192
    s_add_u32 s53, s3, s49
    s_add_u32 m0, s59, 16384
    s_nop 0
    buffer_load_dwordx4 v9, s[8:11], s53 offen offset:0 lds
    buffer_load_dwordx4 v9, s[8:11], s53 offen offset:1024 lds
    s_add_u32 s3, s58, 1
    s_and_b32 s3, s3, 7
    s_lshl_b32 s3, s3, 7
    s_add_u32 s52, s3, s48
    s_add_u32 m0, s51, 32768
    s_nop 0
    buffer_load_dwordx4 v20, s[4:7], s52 offen offset:0 lds
    buffer_load_dwordx4 v21, s[4:7], s52 offen offset:1024 lds
    buffer_load_dwordx4 v22, s[4:7], s52 offen offset:2048 lds
    buffer_load_dwordx4 v23, s[4:7], s52 offen offset:3072 lds
    s_add_u32 s3, s58, 1
    s_and_b32 s3, s3, 7
    s_mul_i32 s3, s3, 8192
    s_add_u32 s53, s3, s49
    s_add_u32 m0, s59, 49152
    s_nop 0
    buffer_load_dwordx4 v9, s[8:11], s53 offen offset:0 lds
    buffer_load_dwordx4 v9, s[8:11], s53 offen offset:1024 lds
    s_add_u32 s3, s58, 2
    s_and_b32 s3, s3, 7
    s_lshl_b32 s3, s3, 7
    s_add_u32 s52, s3, s48
    s_add_u32 m0, s51, 65536
    s_nop 0
    buffer_load_dwordx4 v20, s[4:7], s52 offen offset:0 lds
    buffer_load_dwordx4 v21, s[4:7], s52 offen offset:1024 lds
    buffer_load_dwordx4 v22, s[4:7], s52 offen offset:2048 lds
    buffer_load_dwordx4 v23, s[4:7], s52 offen offset:3072 lds
    s_add_u32 s3, s58, 2
    s_and_b32 s3, s3, 7
    s_mul_i32 s3, s3, 8192
    s_add_u32 s53, s3, s49
    s_add_u32 m0, s59, 81920
    s_nop 0
    buffer_load_dwordx4 v9, s[8:11], s53 offen offset:0 lds
    buffer_load_dwordx4 v9, s[8:11], s53 offen offset:1024 lds
    s_waitcnt vmcnt(12) lgkmcnt(0)
    s_barrier
    s_mov_b64 s[12:13], s[90:91]
    s_mov_b32 s14, 22872064
    s_mov_b32 s15, 0x20000
    s_add_u32 s66, s66, 1
    s_or_b32 s66, s66, 1
    v_mov_b32_e64 v68, 0
    v_mov_b32 v2, 158464
    ds_write_b32 v2, v68
    ds_write_b32 v2, v68 offset:4
    s_lshl_b32 s3, s2, 2
    s_add_u32 s3, s3, s37
    s_lshl_b32 s3, s3, 7
    s_add_u32 s3, s3, 22609920
    s_lshl_b32 s40, s37, 8
    s_add_u32 s40, s40, s2
    s_lshl_b32 s40, s40, 7
    s_add_u32 s40, s40, 22740992
    v_and_b32 v2, 31, v1
    v_mov_b32 v3, s3
    v_mov_b32_e64 v4, s40
    v_cmp_gt_u32 vcc, 32, v1
    s_nop 1
    v_cndmask_b32 v3, v4, v3, vcc
    v_lshl_add_u32 v3, v2, 2, v3
    buffer_store_dword v68, v3, s[12:15], 0 offen sc1
    s_add_u32 s3, s58, 3
    s_and_b32 s3, s3, 7
    s_lshl_b32 s3, s3, 7
    s_add_u32 s52, s3, s48
    s_add_u32 m0, s51, 98304
    s_nop 0
    buffer_load_dwordx4 v20, s[4:7], s52 offen offset:0 lds
    buffer_load_dwordx4 v21, s[4:7], s52 offen offset:1024 lds
    buffer_load_dwordx4 v22, s[4:7], s52 offen offset:2048 lds
    buffer_load_dwordx4 v23, s[4:7], s52 offen offset:3072 lds
    s_add_u32 s3, s58, 3
    s_and_b32 s3, s3, 7
    s_mul_i32 s3, s3, 8192
    s_add_u32 s53, s3, s49
    s_add_u32 m0, s59, 114688
    s_nop 0
    buffer_load_dwordx4 v9, s[8:11], s53 offen offset:0 lds
    buffer_load_dwordx4 v9, s[8:11], s53 offen offset:1024 lds
    s_waitcnt vmcnt(13) lgkmcnt(0)
    s_barrier
    s_add_u32 s3, s58, 4
    s_and_b32 s3, s3, 7
    s_lshl_b32 s3, s3, 7
    s_add_u32 s52, s3, s48
    s_add_u32 m0, s51, 0
    s_nop 0
    buffer_load_dwordx4 v20, s[4:7], s52 offen offset:0 lds
    buffer_load_dwordx4 v21, s[4:7], s52 offen offset:1024 lds
    buffer_load_dwordx4 v22, s[4:7], s52 offen offset:2048 lds
    buffer_load_dwordx4 v23, s[4:7], s52 offen offset:3072 lds
    s_add_u32 s3, s58, 4
    s_and_b32 s3, s3, 7
    s_mul_i32 s3, s3, 8192
    s_add_u32 s53, s3, s49
    s_add_u32 m0, s59, 16384
    s_nop 0
    buffer_load_dwordx4 v9, s[8:11], s53 offen offset:0 lds
    buffer_load_dwordx4 v9, s[8:11], s53 offen offset:1024 lds
    s_waitcnt vmcnt(13)
    s_barrier
    v_and_b32 v2, 15, v1
    v_cmp_gt_u32 vcc, 16, v1
    s_lshl_b32 s3, s37, 7
    s_add_u32 s3, s3, 157952
    v_mov_b32_e64 v3, s3
    v_mov_b32 v4, 157696
    v_cndmask_b32 v3, v4, v3, vcc
    v_lshl_add_u32 v3, v2, 3, v3
    ds_read_b64 v[62:63], v3
    s_lshl_b32 s3, s34, 2
    s_add_u32 s3, s3, s35
    s_lshl_b32 s3, s3, 1
    s_add_u32 s3, s3, s55
    s_lshl_b32 s3, s3, 3
    s_add_u32 s3, s3, s36
    s_lshl_b32 s3, s3, 7
    s_add_u32 s3, s3, 22282240
    v_mov_b32 v4, s3
    v_lshl_add_u32 v69, v2, 4, v4
    v_mov_b32 v64, s66
    v_mov_b32 v65, s66
    s_cmp_eq_u32 s37, 0
    s_cselect_b32 s40, 0xff0000, 0
    s_mov_b32 s41, 0
    s_cbranch_scc0 K1_NOPUBD
    s_mov_b64 exec, s[40:41]
    s_waitcnt lgkmcnt(0)
    buffer_store_dwordx4 v[62:65], v69, s[12:15], 0 offen sc1
    s_mov_b64 exec, -1
K1_NOPUBD:
    s_add_u32 s3, s58, 5
    s_and_b32 s3, s3, 7
    s_lshl_b32 s3, s3, 7
    s_add_u32 s52, s3, s48
    s_add_u32 m0, s51, 32768
    s_nop 0
    buffer_load_dwordx4 v20, s[4:7], s52 offen offset:0 lds
    buffer_load_dwordx4 v21, s[4:7], s52 offen offset:1024 lds
    buffer_load_dwordx4 v22, s[4:7], s52 offen offset:2048 lds
    buffer_load_dwordx4 v23, s[4:7], s52 offen offset:3072 lds
    s_add_u32 s3, s58, 5
    s_and_b32 s3, s3, 7
    s_mul_i32 s3, s3, 8192
    s_add_u32 s53, s3, s49
    s_add_u32 m0, s59, 49152
    s_nop 0
    buffer_load_dwordx4 v9, s[8:11], s53 offen offset:0 lds
    buffer_load_dwordx4 v9, s[8:11], s53 offen offset:1024 lds
    s_waitcnt vmcnt(12) lgkmcnt(0)
    s_barrier
    s_add_u32 s3, s58, 6
    s_and_b32 s3, s3, 7
    s_lshl_b32 s3, s3, 7
    s_add_u32 s52, s3, s48
    s_add_u32 m0, s51, 65536
    s_nop 0
    buffer_load_dwordx4 v20, s[4:7], s52 offen offset:0 lds
    buffer_load_dwordx4 v21, s[4:7], s52 offen offset:1024 lds
    buffer_load_dwordx4 v22, s[4:7], s52 offen offset:2048 lds
    buffer_load_dwordx4 v23, s[4:7], s52 offen offset:3072 lds
    s_add_u32 s3, s58, 6
    s_and_b32 s3, s3, 7
    s_mul_i32 s3, s3, 8192
    s_add_u32 s53, s3, s49
    s_add_u32 m0, s59, 81920
    s_nop 0
    buffer_load_dwordx4 v9, s[8:11], s53 offen offset:0 lds
    buffer_load_dwordx4 v9, s[8:11], s53 offen offset:1024 lds
    s_waitcnt vmcnt(12)
    s_barrier
    s_add_u32 s3, s58, 7
    s_and_b32 s3, s3, 7
    s_lshl_b32 s3, s3, 7
    s_add_u32 s52, s3, s48
    s_add_u32 m0, s51, 98304
    s_nop 0
    buffer_load_dwordx4 v20, s[4:7], s52 offen offset:0 lds
    buffer_load_dwordx4 v21, s[4:7], s52 offen offset:1024 lds
    buffer_load_dwordx4 v22, s[4:7], s52 offen offset:2048 lds
    buffer_load_dwordx4 v23, s[4:7], s52 offen offset:3072 lds
    s_add_u32 s3, s58, 7
    s_and_b32 s3, s3, 7
    s_mul_i32 s3, s3, 8192
    s_add_u32 s53, s3, s49
    s_add_u32 m0, s59, 114688
    s_nop 0
    buffer_load_dwordx4 v9, s[8:11], s53 offen offset:0 lds
    buffer_load_dwordx4 v9, s[8:11], s53 offen offset:1024 lds
    s_waitcnt vmcnt(12)
    s_barrier
    s_waitcnt vmcnt(6)
    s_barrier
    s_waitcnt vmcnt(0)
    s_barrier
    s_mov_b64 s[16:17], s[26:27]
    s_mov_b32 s18, 1052672
    s_mov_b32 s19, 0x20000
    s_mov_b64 s[44:45], s[22:23]
    s_mov_b64 s[20:21], s[44:45]
    s_mov_b32 s22, 1052672
    s_mov_b32 s23, 0x20000
    s_and_b32 s84, s2, 3
    s_lshl_b32 s45, s84, 7
    s_add_u32 s45, s45, 2
    v_and_b32 v2, 31, v1
    v_lshl_add_u32 v3, v2, 2, s45
    s_movk_i32 s45, 514
    v_mad_u32_u24 v44, v5, s45, v3
    s_bfe_u32 s45, s2, 0x30002
    s_lshl_b32 s63, s45, 2
    s_add_u32 s63, s63, s37
    s_lshl_b32 s63, s63, 1
    s_lshl_b32 s44, s36, 8
    s_add_u32 s63, s63, s44
    s_mul_i32 s44, s63, 514
    s_add_u32 s45, s44, 32896
    s_add_u32 s46, s44, 65792
    s_add_u32 s47, s44, 98688
    buffer_load_dword v28, v44, s[16:19], s44 offen
    buffer_load_dword v32, v44, s[20:23], s44 offen
    buffer_load_dword v29, v44, s[16:19], s45 offen
    buffer_load_dword v33, v44, s[20:23], s45 offen
    buffer_load_dword v30, v44, s[16:19], s46 offen
    buffer_load_dword v34, v44, s[20:23], s46 offen
    buffer_load_dword v31, v44, s[16:19], s47 offen
    buffer_load_dword v35, v44, s[20:23], s47 offen
    s_mov_b64 s[92:93], s[30:31]
    s_mov_b32 s94, 1835008
    s_mov_b32 s95, 0x20000
    s_lshl_b32 s3, s2, 2
    s_add_u32 s3, s3, s37
    s_mul_i32 s54, s3, 1792
    buffer_load_dwordx4 v[46:49], v9, s[92:95], s54 offen offset:0
    buffer_load_dwordx4 v[46:49], v9, s[92:95], s54 offen offset:1024
    v_lshrrev_b32 v3, 4, v1
    v_and_b32 v2, 7, v1
    v_xor_b32 v4, v2, v3
    v_lshrrev_b32 v6, 3, v1
    s_lshl_b32 s3, s37, 13
    s_add_u32 s3, s3, 0
    v_lshl_add_u32 v6, v6, 7, s3
    v_lshl_add_u32 v70, v4, 4, v6
    v_xor_b32 v71, 64, v70
    s_and_b32 s46, s37, 1
    s_lshr_b32 s47, s37, 1
    v_lshlrev_b32 v2, 4, v2
    v_bfe_u32 v4, v1, 3, 1
    v_lshl_add_u32 v2, v4, 12, v2
    s_mul_i32 s3, s46, 3
    v_xor_b32 v4, s3, v3
    v_lshl_add_u32 v72, v4, 13, v2
    s_lshl_b32 s40, s55, 5
    s_lshl_b32 s42, s47, 7
    s_add_u32 s41, s40, s42
    s_sub_u32 s42, 251, s41
    s_cmp_eq_u32 s46, 0
    s_cselect_b32 s41, s41, s42
    s_mov_b32 s43, 0x8000
    s_cselect_b32 s43, s43, 0xffff8000
    s_lshl_b32 s41, s41, 13
    s_lshr_b32 s42, s35, 1
    s_lshl_b32 s42, s42, 11
    s_add_u32 s41, s41, s42
    s_lshl_b32 s42, s34, 9
    s_add_u32 s41, s41, s42
    s_and_b32 s42, s35, 1
    s_lshl_b32 s42, s42, 8
    s_add_u32 s41, s41, s42
    s_add_u32 s41, s41, 7340032
    s_lshl_b32 s42, s47, 6
    s_add_u32 s40, s40, s42
    v_add_u32 v3, s40, v3
    v_cmp_eq_u32 vcc, 99, v3
    v_add_u32 v2, 524288, v72
    s_nop 0
    v_cndmask_b32 v73, v72, v2, vcc
    s_barrier
    ds_read_b128 v[74:77], v70 offset:0
    ds_read_b128 v[78:81], v71 offset:1024
    ds_read_b128 v[82:85], v70 offset:2048
    ds_read_b128 v[86:89], v71 offset:3072
    ds_read_b128 v[90:93], v70 offset:4096
    ds_read_b128 v[94:97], v71 offset:5120
    ds_read_b128 v[98:101], v70 offset:6144
    ds_read_b128 v[102:105], v71 offset:7168
    s_waitcnt lgkmcnt(7)
    buffer_store_dwordx4 v[74:77], v72, s[12:15], s41 offen sc1
    s_add_u32 s41, s41, s43
    s_waitcnt lgkmcnt(6)
    buffer_store_dwordx4 v[78:81], v72, s[12:15], s41 offen sc1
    s_add_u32 s41, s41, s43
    s_waitcnt lgkmcnt(5)
    buffer_store_dwordx4 v[82:85], v72, s[12:15], s41 offen sc1
    s_add_u32 s41, s41, s43
    s_waitcnt lgkmcnt(4)
    buffer_store_dwordx4 v[86:89], v72, s[12:15], s41 offen sc1
    s_add_u32 s41, s41, s43
    s_waitcnt lgkmcnt(3)
    buffer_store_dwordx4 v[90:93], v72, s[12:15], s41 offen sc1
    s_add_u32 s41, s41, s43
    s_waitcnt lgkmcnt(2)
    buffer_store_dwordx4 v[94:97], v72, s[12:15], s41 offen sc1
    s_add_u32 s41, s41, s43
    s_waitcnt lgkmcnt(1)
    buffer_store_dwordx4 v[98:101], v72, s[12:15], s41 offen sc1
    s_add_u32 s41, s41, s43
    s_waitcnt lgkmcnt(0)
    buffer_store_dwordx4 v[102:105], v73, s[12:15], s41 offen sc1
    s_barrier
    s_mov_b32 s86, 0x05040100
    s_mov_b32 s87, 0x07060302
    s_lshl_b32 s3, s37, 1
    v_and_b32 v2, 7, v1
    v_xor_b32 v2, v2, v5
    v_xor_b32 v2, s3, v2
    v_and_b32 v3, 31, v1
    v_lshlrev_b32_e64 v3, 8, v3
    v_lshl_add_u32 v44, v2, 4, v3
    s_waitcnt vmcnt(16)
    v_perm_b32 v36, v32, v28, s86
    s_waitcnt vmcnt(14)
    v_perm_b32 v37, v33, v29, s86
    s_waitcnt vmcnt(12)
    v_perm_b32 v38, v34, v30, s86
    s_waitcnt vmcnt(10)
    v_perm_b32 v39, v35, v31, s86
    ds_write_b128 v44, v[36:39] offset:0
    v_perm_b32 v40, v32, v28, s87
    v_perm_b32 v41, v33, v29, s87
    v_perm_b32 v42, v34, v30, s87
    v_perm_b32 v43, v35, v31, s87
    ds_write_b128 v44, v[40:43] offset:128
    s_waitcnt lgkmcnt(0)
    s_barrier
    s_lshl_b32 s84, s84, 2
    s_add_u32 s84, s84, s37
    s_lshl_b32 s84, s84, 17
    s_lshl_b32 s63, s35, 11
    s_add_u32 s84, s84, s63
    s_lshr_b32 s63, s2, 7
    s_lshl_b32 s63, s63, 10
    s_add_u32 s84, s84, s63
    s_bfe_u32 s63, s2, 0x20005
    s_lshl_b32 s63, s63, 8
    s_add_u32 s84, s84, s63
    s_bfe_u32 s63, s2, 0x10002
    s_lshl_b32 s63, s63, 7
    s_add_u32 s84, s84, s63
    s_add_u32 s84, s84, 9437184
    s_add_u32 s85, s84, 65536
    v_lshrrev_b32 v3, 4, v1
    v_and_b32 v2, 7, v1
    v_xor_b32 v3, v3, v2
    v_lshrrev_b32 v4, 3, v1
    s_lshl_b32 s3, s37, 11
    v_lshl_add_u32 v44, v4, 7, s3
    v_lshl_add_u32 v44, v3, 4, v44
    v_xor_b32 v3, 64, v44
    ds_read_b128 v[28:31], v44 offset:0
    ds_read_b128 v[32:35], v3 offset:1024
    v_lshlrev_b32_e64 v2, 4, v2
    v_lshl_add_u32 v45, v4, 13, v2
    s_waitcnt lgkmcnt(1)
    buffer_store_dwordx4 v[28:31], v45, s[12:15], s84 offen sc1
    s_waitcnt lgkmcnt(0)
    buffer_store_dwordx4 v[32:35], v45, s[12:15], s85 offen sc1
    s_bfe_u32 s32, s2, 0x20001
    s_and_b32 s3, s2, 1
    s_lshl_b32 s3, s3, 3
    s_lshr_b32 s33, s2, 5
    s_add_u32 s33, s33, s3
    s_bfe_u32 s64, s2, 0x20003
    s_lshl_b32 s65, s33, 2
    s_add_u32 s65, s65, s32
    s_mov_b64 s[16:17], s[30:31]
    s_mov_b32 s18, 1835008
    s_mov_b32 s19, 0x20000
    s_mul_i32 s3, s32, 448
    s_lshl_b32 s40, s37, 4
    s_add_u32 s3, s3, s40
    s_lshl_b32 s3, s3, 3
    s_add_u32 s3, s3, s64
    s_lshl_b32 s61, s3, 7
    s_lshl_b32 s3, s64, 1
    s_lshr_b32 s40, s2, 5
    s_add_u32 s3, s3, s40
    s_mul_i32 s3, s3, 0
    s_cmp_ge_u32 s3, 7
    s_cselect_b32 s40, 7, 0
    s_sub_u32 s50, s3, s40
    s_lshl_b32 s3, s50, 16
    s_add_u32 s61, s61, s3
    v_lshrrev_b32 v3, 4, v1
    v_and_b32 v2, 15, v1
    v_lshlrev_b32 v4, 2, v3
    v_xor_b32 v2, v2, v4
    v_lshrrev_b32 v4, 3, v2
    v_and_b32 v2, 7, v2
    v_lshlrev_b32_e64 v2, 4, v2
    v_lshl_add_u32 v2, v4, 9, v2
    v_lshl_add_u32 v10, v3, 10, v2
    v_add_u32 v11, 3072, v10
    v_add_u32 v12, 6144, v10
    v_add_u32 v13, 9216, v10
    s_waitcnt vmcnt(0)
    s_barrier
    s_cmp_lg_u32 s37, 3
    s_cbranch_scc1 K1_FX
    s_lshl_b32 s3, s2, 7
    s_add_u32 s3, s3, 22839296
    v_lshlrev_b32 v2, 2, v1
    v_mov_b32_e64 v4, s66
    s_mov_b64 exec, 0xffffffff
    buffer_store_dword v4, v2, s[12:15], s3 offen sc1
    s_mov_b64 exec, -1
K1_FX:
    s_lshl_b32 s3, s2, 2
    s_add_u32 s3, s3, s37
    s_lshl_b32 s3, s3, 7
    s_add_u32 s3, s3, 22609920
    v_lshlrev_b32 v2, 2, v1
    v_mov_b32 v4, s66
    s_mov_b64 exec, 0xffffffff
    buffer_store_dword v4, v2, s[12:15], s3 offen sc1
    s_mov_b64 exec, -1
    s_add_u32 m0, s51, 49152
    s_nop 0
    buffer_load_dwordx4 v10, s[16:19], s61 offen offset:0 lds
    buffer_load_dwordx4 v11, s[16:19], s61 offen offset:1024 lds
    buffer_load_dwordx4 v12, s[16:19], s61 offen offset:2048 lds
    buffer_load_dwordx4 v13, s[16:19], s61 offen offset:3072 lds
    s_add_u32 s61, s61, 65536
    s_add_u32 m0, s51, 65536
    s_nop 0
    buffer_load_dwordx4 v10, s[16:19], s61 offen offset:0 lds
    buffer_load_dwordx4 v11, s[16:19], s61 offen offset:1024 lds
    buffer_load_dwordx4 v12, s[16:19], s61 offen offset:2048 lds
    buffer_load_dwordx4 v13, s[16:19], s61 offen offset:3072 lds
    s_add_u32 s61, s61, 65536
    s_add_u32 m0, s51, 81920
    s_nop 0
    buffer_load_dwordx4 v10, s[16:19], s61 offen offset:0 lds
    buffer_load_dwordx4 v11, s[16:19], s61 offen offset:1024 lds
    buffer_load_dwordx4 v12, s[16:19], s61 offen offset:2048 lds
    buffer_load_dwordx4 v13, s[16:19], s61 offen offset:3072 lds
    s_add_u32 s61, s61, 65536
    s_and_b32 s3, s33, 3
    s_lshl_b32 s3, s3, 3
    s_lshr_b32 s43, s33, 2
    s_lshl_b32 s43, s43, 1
    s_add_u32 s3, s3, s43
    s_lshr_b32 s43, s32, 1
    s_add_u32 s3, s3, s43
    s_and_b32 s43, s32, 1
    s_mul_i32 s43, s43, 96
    s_add_u32 s3, s3, s43
    s_lshl_b32 s3, s3, 7
    s_add_u32 s3, s3, 22773760
    v_and_b32 v2, 3, v1
    v_lshl_add_u32 v18, v2, 12, s3
    s_mov_b64 exec, 15
    buffer_load_dword v15, v18, s[12:15], 0 offen sc1
    s_mov_b64 exec, -1
    s_lshl_b32 s3, s33, 2
    s_lshr_b32 s43, s37, 1
    s_add_u32 s3, s3, s43
    s_mul_i32 s3, s3, 112
    s_mul_i32 s43, s32, 28
    s_add_u32 s3, s3, s43
    s_and_b32 s43, s37, 1
    s_lshl_b32 s43, s43, 1
    s_add_u32 s3, s3, s43
    s_lshl_b32 s43, s50, 2
    s_add_u32 s3, s3, s43
    s_lshl_b32 s60, s3, 10
    s_lshl_b32 s44, s37, 11
    s_lshl_b32 s43, s2, 13
    s_add_u32 s43, s43, s44
    s_add_u32 s47, s43, 7340032
    s_add_u32 s48, s43, 9437184
    s_lshr_b32 s3, s2, 4
    s_lshl_b32 s43, s37, 5
    s_add_u32 s3, s3, s43
    s_lshl_b32 s3, s3, 7
    s_add_u32 s3, s3, 22609920
    v_and_b32_e64 v2, 1, v1
    v_lshl_add_u32 v14, v2, 11, s3
    v_bfe_u32 v2, v1, 1, 3
    v_lshl_add_u32 v14, v2, 14, v14
    s_add_u32 s3, s2, 1
    s_and_b32 s3, s3, 127
    s_sub_u32 s43, 128, s3
    s_min_u32 s3, s3, s43
    s_sub_u32 s3, s3, 1
    s_bfe_u32 s3, s3, 0x10005
    s_and_b32 s43, s37, 1
    s_lshl_b32 s43, s43, 4
    s_add_u32 s3, s3, s43
    s_add_u32 s3, s3, 224
    s_lshl_b32 s3, s3, 7
    s_add_u32 s3, s3, 22839296
    v_and_b32 v2, 7, v1
    v_lshl_add_u32 v16, v2, 8, s3
    v_cmp_gt_u32 vcc, 16, v1
    s_nop 1
    v_cndmask_b32 v14, v16, v14, vcc
    s_mov_b64 exec, 15
    s_waitcnt vmcnt(0)
    v_cmp_ne_u32 vcc, s66, v15
    s_cbranch_vccz P2_FAD_END0
    s_mov_b32 s67, 0
P2_FAD_SPIN0:
    s_mov_b64 exec, vcc
    s_sleep 4
    buffer_load_dword v15, v18, s[12:15], 0 offen sc1
    s_add_u32 s67, s67, 1
    s_cmp_gt_u32 s67, 20000
    s_waitcnt vmcnt(0)
    s_cbranch_scc1 P2_FAD_END0
    v_cmp_ne_u32 vcc, s66, v15
    s_cbranch_vccnz P2_FAD_SPIN0
P2_FAD_END0:
    s_mov_b64 exec, -1
    s_branch P2_LOADER
K1_COMPUTE:
    s_lshl_b32 s3, s34, 2
    s_add_u32 s3, s3, s35
    s_lshl_b32 s3, s3, 1
    s_add_u32 s3, s3, s55
    s_lshl_b32 s3, s3, 3
    s_add_u32 s3, s3, s36
    s_lshl_b32 s3, s3, 2
    s_add_u32 s3, s3, s37
    s_lshl_b32 s3, s3, 11
    v_lshlrev_b32 v2, 4, v1
    s_mov_b32 s6, 0x200000
    s_mov_b32 s7, 0x20000
    s_waitcnt lgkmcnt(0)
    s_mov_b64 s[4:5], s[24:25]
    buffer_load_dwordx4 v[80:83], v2, s[4:7], s3 offen
    buffer_load_dwordx4 v[84:87], v2, s[4:7], s3 offen offset:1024
    v_mov_b32 v16, 0
    s_add_u32 s88, s90, 22020096
    s_addc_u32 s89, s91, 0
    s_load_dword s66, s[88:89], 294912
    s_mov_b64 s[12:13], s[90:91]
    s_mov_b32 s14, 22872064
    s_mov_b32 s15, 0x20000
    s_lshl_b32 s3, s2, 2
    s_add_u32 s3, s3, s37
    s_lshl_b32 s3, s3, 7
    s_add_u32 s3, s3, 22347776
    v_and_b32 v3, 31, v1
    v_lshlrev_b32 v3, 2, v3
    v_lshl_add_u32 v3, v5, 17, v3
    buffer_store_dword v16, v3, s[12:15], s3 offen sc1
    v_mov_b32 v10, 0x3f803f80
    v_mov_b32 v11, 0x3f803f80
    v_and_b32 v3, 1, v1
    v_cmp_eq_u32 s[58:59], 1, v3
    v_bfe_u32 v6, v1, 1, 3
    v_and_b32 v2, 31, v1
    v_lshlrev_b32 v2, 7, v2
    s_cmp_eq_u32 s36, 7
    s_cbranch_scc1 K1_DFT
    s_lshr_b32 s38, s37, 1
    s_and_b32 s39, s37, 1
    s_lshl_b32 s3, s38, 12
    v_add_u32 v2, s3, v2
    v_xor_b32 v3, v5, v6
    v_xor_b32 v4, 0, v3
    v_lshl_add_u32 v18, v4, 4, v2
    v_add_u32 v22, 65536, v18
    v_add_u32 v26, 131072, v18
    v_xor_b32 v4, 2, v3
    v_lshl_add_u32 v19, v4, 4, v2
    v_add_u32 v23, 65536, v19
    v_add_u32 v27, 131072, v19
    v_xor_b32 v4, 4, v3
    v_lshl_add_u32 v20, v4, 4, v2
    v_add_u32 v24, 65536, v20
    v_add_u32 v28, 131072, v20
    v_xor_b32 v4, 6, v3
    v_lshl_add_u32 v21, v4, 4, v2
    v_add_u32 v25, 65536, v21
    v_add_u32 v29, 131072, v21
    v_and_b32 v3, 2, v1
    v_cmp_eq_u32 s[62:63], 2, v3
    v_bfe_u32 v2, v1, 2, 2
    v_lshl_add_u32 v3, v5, 3, v2
    v_lshlrev_b32 v3, 8, v3
    s_lshl_b32 s3, s39, 1
    s_add_u32 s54, s3, s38
    v_xor_b32_e64 v2, s54, v2
    v_lshl_add_u32 v3, v2, 6, v3
    v_bfe_u32 v2, v1, 4, 1
    v_lshl_add_u32 v3, v2, 5, v3
    v_and_b32 v2, 1, v1
    v_lshl_add_u32 v3, v2, 4, v3
    v_bfe_u32 v2, v1, 1, 1
    v_lshl_add_u32 v30, v2, 3, v3
    v_xor_b32 v31, 64, v30
    v_add_u32 v32, 65536, v30
    v_add_u32 v33, 65536, v31
    v_and_b32 v2, 31, v1
    s_lshl_b32 s3, s38, 8
    s_add_u32 s3, s3, 155648
    v_lshl_add_u32 v176, v2, 3, s3
    s_lshl_b32 s3, s54, 7
    s_add_u32 s40, s3, 157952
    v_lshl_add_u32 v177, v2, 2, s40
    s_add_u32 s3, s3, 156672
    v_lshl_add_u32 v178, v5, 4, s3
    v_xor_b32 v179, 0x80, v178
    s_mov_b32 s60, 0xbfb8aa3b
    s_mov_b32 s61, 0xbfb8aa3b
    v_lshlrev_b32_e64 v34, 4, v1
    s_lshl_b32 s3, s34, 2
    s_add_u32 s3, s3, s35
    s_lshl_b32 s3, s3, 2
    s_add_u32 s40, s3, s38
    s_mul_i32 s40, s40, 114688
    s_mul_i32 s3, s55, 7
    s_add_u32 s3, s3, s36
    s_lshl_b32 s3, s3, 13
    s_lshl_b32 s42, s54, 11
    s_add_u32 s42, s42, s3
    s_xor_b32 s43, s42, 0x800
    s_add_u32 s44, s40, s42
    s_add_u32 s45, s40, s43
    s_add_u32 s46, s44, 229376
    s_add_u32 s47, s45, 229376
    v_lshrrev_b32 v3, 4, v1
    v_and_b32 v2, 15, v1
    v_cvt_f32_u32 v40, v2
    v_cvt_f32_u32 v41, v3
    s_lshl_b32 s3, s37, 4
    v_add_u32 v2, s3, v2
    v_cvt_f32_u32_e64 v42, v2
    v_mul_f32 v4, 0x3c800000, v42
    v_mul_f32 v60, 0x41000000, v41
    v_mul_f32 v7, v60, v4
    v_mov_b32 v43, v7
    v_cos_f32 v44, v43
    v_sin_f32 v52, v43
    v_fma_f32 v43, 1.0, v4, v7
    v_cos_f32 v45, v43
    v_sin_f32 v53, v43
    v_fma_f32 v43, 2.0, v4, v7
    v_cos_f32 v46, v43
    v_sin_f32 v54, v43
    v_mov_b32 v6, 0x40400000
    v_fma_f32 v43, v6, v4, v7
    v_cos_f32 v47, v43
    v_sin_f32 v55, v43
    v_fma_f32 v43, 4.0, v4, v7
    v_cos_f32 v48, v43
    v_sin_f32 v56, v43
    v_mov_b32 v6, 0x40a00000
    v_fma_f32 v43, v6, v4, v7
    v_cos_f32 v49, v43
    v_sin_f32 v57, v43
    v_mov_b32 v6, 0x40c00000
    v_fma_f32 v43, v6, v4, v7
    v_cos_f32 v50, v43
    v_sin_f32 v58, v43
    v_mov_b32 v6, 0x40e00000
    v_fma_f32 v43, v6, v4, v7
    v_cos_f32 v51, v43
    v_sin_f32 v59, v43
    v_cvt_pk_bf16_f32 v192, v44, v45
    v_cvt_pk_bf16_f32 v200, v52, v53
    v_cvt_pk_bf16_f32 v193, v46, v47
    v_cvt_pk_bf16_f32 v201, v54, v55
    v_cvt_pk_bf16_f32 v194, v48, v49
    v_cvt_pk_bf16_f32 v202, v56, v57
    v_cvt_pk_bf16_f32 v195, v50, v51
    v_cvt_pk_bf16_f32 v203, v58, v59
    v_add_f32 v60, 0x42000000, v60
    v_mul_f32 v7, v60, v4
    v_mov_b32 v43, v7
    v_cos_f32 v44, v43
    v_sin_f32 v52, v43
    v_fma_f32 v43, 1.0, v4, v7
    v_cos_f32 v45, v43
    v_sin_f32 v53, v43
    v_fma_f32 v43, 2.0, v4, v7
    v_cos_f32 v46, v43
    v_sin_f32 v54, v43
    v_mov_b32 v6, 0x40400000
    v_fma_f32 v43, v6, v4, v7
    v_cos_f32 v47, v43
    v_sin_f32 v55, v43
    v_fma_f32 v43, 4.0, v4, v7
    v_cos_f32 v48, v43
    v_sin_f32 v56, v43
    v_mov_b32 v6, 0x40a00000
    v_fma_f32 v43, v6, v4, v7
    v_cos_f32 v49, v43
    v_sin_f32 v57, v43
    v_mov_b32 v6, 0x40c00000
    v_fma_f32 v43, v6, v4, v7
    v_cos_f32 v50, v43
    v_sin_f32 v58, v43
    v_mov_b32 v6, 0x40e00000
    v_fma_f32 v43, v6, v4, v7
    v_cos_f32 v51, v43
    v_sin_f32 v59, v43
    v_cvt_pk_bf16_f32 v196, v44, v45
    v_cvt_pk_bf16_f32 v204, v52, v53
    v_cvt_pk_bf16_f32 v197, v46, v47
    v_cvt_pk_bf16_f32 v205, v54, v55
    v_cvt_pk_bf16_f32 v198, v48, v49
    v_cvt_pk_bf16_f32 v206, v56, v57
    v_cvt_pk_bf16_f32 v199, v50, v51
    v_cvt_pk_bf16_f32 v207, v58, v59
    v_mul_f32 v60, 4.0, v41
    v_mul_f32 v4, 0x3d000000, v40
    v_mul_f32 v7, v60, v4
    v_mov_b32 v43, v7
    v_cos_f32 v44, v43
    v_sin_f32 v52, v43
    v_fma_f32 v43, 1.0, v4, v7
    v_cos_f32 v45, v43
    v_sin_f32 v53, v43
    v_fma_f32 v43, 2.0, v4, v7
    v_cos_f32 v46, v43
    v_sin_f32 v54, v43
    v_mov_b32 v6, 0x40400000
    v_fma_f32 v43, v6, v4, v7
    v_cos_f32 v47, v43
    v_sin_f32 v55, v43
    v_mov_b32 v6, 0x41800000
    v_fma_f32 v43, v6, v4, v7
    v_cos_f32 v48, v43
    v_sin_f32 v56, v43
    v_mov_b32 v6, 0x41880000
    v_fma_f32 v43, v6, v4, v7
    v_cos_f32 v49, v43
    v_sin_f32 v57, v43
    v_mov_b32 v6, 0x41900000
    v_fma_f32 v43, v6, v4, v7
    v_cos_f32 v50, v43
    v_sin_f32_e64 v58, v43
    v_mov_b32 v6, 0x41980000
    v_fma_f32 v43, v6, v4, v7
    v_cos_f32 v51, v43
    v_sin_f32 v59, v43
    v_cvt_pk_bf16_f32 v208, v44, v45
    v_cvt_pk_bf16_f32 v216, v52, v53
    v_cvt_pk_bf16_f32 v209, v46, v47
    v_cvt_pk_bf16_f32 v217, v54, v55
    v_cvt_pk_bf16_f32 v210, v48, v49
    v_cvt_pk_bf16_f32 v218, v56, v57
    v_cvt_pk_bf16_f32 v211, v50, v51
    v_cvt_pk_bf16_f32 v219, v58, v59
    v_mul_f32 v4, 0x3d000000, v40
    v_add_f32 v4, 0.5, v4
    v_mul_f32 v7, v60, v4
    v_mov_b32 v43, v7
    v_cos_f32 v44, v43
    v_sin_f32 v52, v43
    v_fma_f32 v43, 1.0, v4, v7
    v_cos_f32 v45, v43
    v_sin_f32_e64 v53, v43
    v_fma_f32 v43, 2.0, v4, v7
    v_cos_f32 v46, v43
    v_sin_f32 v54, v43
    v_mov_b32 v6, 0x40400000
    v_fma_f32 v43, v6, v4, v7
    v_cos_f32 v47, v43
    v_sin_f32 v55, v43
    v_mov_b32 v6, 0x41800000
    v_fma_f32 v43, v6, v4, v7
    v_cos_f32 v48, v43
    v_sin_f32 v56, v43
    v_mov_b32 v6, 0x41880000
    v_fma_f32 v43, v6, v4, v7
    v_cos_f32 v49, v43
    v_sin_f32 v57, v43
    v_mov_b32 v6, 0x41900000
    v_fma_f32 v43, v6, v4, v7
    v_cos_f32 v50, v43
    v_sin_f32 v58, v43
    v_mov_b32 v6, 0x41980000
    v_fma_f32 v43, v6, v4, v7
    v_cos_f32 v51, v43
    v_sin_f32 v59, v43
    v_cvt_pk_bf16_f32 v212, v44, v45
    v_cvt_pk_bf16_f32 v220, v52, v53
    v_cvt_pk_bf16_f32 v213, v46, v47
    v_cvt_pk_bf16_f32 v221, v54, v55
    v_cvt_pk_bf16_f32 v214, v48, v49
    v_cvt_pk_bf16_f32 v222, v56, v57
    v_cvt_pk_bf16_f32 v215, v50, v51
    v_cvt_pk_bf16_f32 v223, v58, v59
    v_mul_f32 v4, 0x3a000000, v42
    v_mul_f32 v7, v60, v4
    v_mov_b32 v6, 0x00000000
    v_fma_f32 v43, v6, v4, v7
    v_cos_f32 v224, v43
    v_sin_f32 v232, v43
    v_mov_b32 v6, 0x3f800000
    v_fma_f32 v43, v6, v4, v7
    v_cos_f32 v225, v43
    v_sin_f32 v233, v43
    v_mov_b32 v6, 0x40000000
    v_fma_f32 v43, v6, v4, v7
    v_cos_f32 v226, v43
    v_sin_f32 v234, v43
    v_mov_b32 v6, 0x40400000
    v_fma_f32 v43, v6, v4, v7
    v_cos_f32 v227, v43
    v_sin_f32 v235, v43
    v_mov_b32 v6, 0x41800000
    v_fma_f32 v43, v6, v4, v7
    v_cos_f32 v228, v43
    v_sin_f32 v236, v43
    v_mov_b32 v6, 0x41880000
    v_fma_f32 v43, v6, v4, v7
    v_cos_f32 v229, v43
    v_sin_f32 v237, v43
    v_mov_b32 v6, 0x41900000
    v_fma_f32 v43, v6, v4, v7
    v_cos_f32 v230, v43
    v_sin_f32 v238, v43
    v_mov_b32 v6, 0x41980000
    v_fma_f32 v43, v6, v4, v7
    v_cos_f32 v231, v43
    v_sin_f32 v239, v43
    v_cvt_f32_u32 v6, s3
    v_add_f32 v60, v60, v6
    v_mul_f32 v4, 0x3a000000, v40
    v_mul_f32 v43, v60, v4
    v_cos_f32 v240, v43
    v_sin_f32 v248, v43
    v_add_f32 v43, v43, v4
    v_cos_f32 v241, v43
    v_sin_f32 v249, v43
    v_add_f32 v43, v43, v4
    v_cos_f32 v242, v43
    v_sin_f32 v250, v43
    v_add_f32 v43, v43, v4
    v_cos_f32 v243, v43
    v_sin_f32 v251, v43
    v_mul_f32 v4, 0x3a000000, v40
    v_add_f32 v4, 0x3c000000, v4
    v_mul_f32 v43, v60, v4
    v_cos_f32 v244, v43
    v_sin_f32 v252, v43
    v_add_f32 v43, v43, v4
    v_cos_f32 v245, v43
    v_sin_f32 v253, v43
    v_add_f32 v43, v43, v4
    v_cos_f32 v246, v43
    v_sin_f32 v254, v43
    v_add_f32 v43, v43, v4
    v_cos_f32 v247, v43
    v_sin_f32 v255, v43
    s_mov_b32 s16, 0x3a000000
    s_mov_b32 s17, 0x3a000000
    v_pk_mul_f32 v[240:241], v[240:241], s[16:17]
    v_pk_mul_f32 v[248:249], v[248:249], s[16:17]
    v_pk_mul_f32 v[242:243], v[242:243], s[16:17]
    v_pk_mul_f32 v[250:251], v[250:251], s[16:17]
    v_pk_mul_f32 v[244:245], v[244:245], s[16:17]
    v_pk_mul_f32 v[252:253], v[252:253], s[16:17]
    v_pk_mul_f32 v[246:247], v[246:247], s[16:17]
    v_pk_mul_f32 v[254:255], v[254:255], s[16:17]
    s_lshl_b32 s33, s2, 2
    s_add_u32 s33, s33, s37
    s_waitcnt vmcnt(2)
    v_dot2_f32_bf16 v12, v80, v80, 0
    v_dot2_f32_bf16 v13, v80, v10, 0
    s_waitcnt vmcnt(1)
    v_dot2_f32_bf16 v14, v84, v84, 0
    v_dot2_f32_bf16 v15, v84, v10, 0
    v_dot2_f32_bf16 v12, v81, v81, v12
    v_dot2_f32_bf16 v13, v81, v10, v13
    v_dot2_f32_bf16 v14, v85, v85, v14
    v_dot2_f32_bf16 v15, v85, v10, v15
    v_dot2_f32_bf16 v12, v82, v82, v12
    v_dot2_f32_bf16 v13, v82, v10, v13
    v_dot2_f32_bf16 v14, v86, v86, v14
    v_dot2_f32_bf16 v15, v86, v10, v15
    v_dot2_f32_bf16 v12, v83, v83, v12
    v_dot2_f32_bf16 v13, v83, v10, v13
    v_dot2_f32_bf16 v14, v87, v87, v14
    v_dot2_f32_bf16 v15, v87, v10, v15
    s_nop 2
    v_add_f32_dpp v12, v12, v12 row_shr:1 row_mask:0xf bank_mask:0xf bound_ctrl:0
    v_add_f32_dpp v13, v13, v13 row_shr:1 row_mask:0xf bank_mask:0xf bound_ctrl:0
    v_add_f32_dpp v14, v14, v14 row_shr:1 row_mask:0xf bank_mask:0xf bound_ctrl:0
    v_add_f32_dpp v15, v15, v15 row_shr:1 row_mask:0xf bank_mask:0xf bound_ctrl:0
    v_add_f32_dpp v12, v12, v12 row_shr:2 row_mask:0xf bank_mask:0xf bound_ctrl:0
    v_add_f32_dpp v13, v13, v13 row_shr:2 row_mask:0xf bank_mask:0xf bound_ctrl:0
    v_add_f32_dpp v14, v14, v14 row_shr:2 row_mask:0xf bank_mask:0xf bound_ctrl:0
    v_add_f32_dpp v15, v15, v15 row_shr:2 row_mask:0xf bank_mask:0xf bound_ctrl:0
    v_add_f32_dpp v12, v12, v12 row_shr:4 row_mask:0xf bank_mask:0xf bound_ctrl:0
    v_add_f32_dpp v13, v13, v13 row_shr:4 row_mask:0xf bank_mask:0xf bound_ctrl:0
    v_add_f32_dpp v14, v14, v14 row_shr:4 row_mask:0xf bank_mask:0xf bound_ctrl:0
    v_add_f32_dpp v15, v15, v15 row_shr:4 row_mask:0xf bank_mask:0xf bound_ctrl:0
    v_add_f32_dpp v12, v12, v12 row_shr:8 row_mask:0xf bank_mask:0xf bound_ctrl:0
    v_add_f32_dpp v13, v13, v13 row_shr:8 row_mask:0xf bank_mask:0xf bound_ctrl:0
    v_add_f32_dpp v14, v14, v14 row_shr:8 row_mask:0xf bank_mask:0xf bound_ctrl:0
    v_add_f32_dpp v15, v15, v15 row_shr:8 row_mask:0xf bank_mask:0xf bound_ctrl:0
    v_add_f32_dpp v12, v12, v12 row_bcast:15 row_mask:0xa bank_mask:0xf bound_ctrl:0
    v_add_f32_dpp v13, v13, v13 row_bcast:15 row_mask:0xa bank_mask:0xf bound_ctrl:0
    v_add_f32_dpp v14, v14, v14 row_bcast:15 row_mask:0xa bank_mask:0xf bound_ctrl:0
    v_add_f32_dpp v15, v15, v15 row_bcast:15 row_mask:0xa bank_mask:0xf bound_ctrl:0
    v_add_f32_dpp v12, v12, v12 row_bcast:31 row_mask:0xc bank_mask:0xf bound_ctrl:0
    v_add_f32_dpp v13, v13, v13 row_bcast:31 row_mask:0xc bank_mask:0xf bound_ctrl:0
    v_add_f32_dpp v14, v14, v14 row_bcast:31 row_mask:0xc bank_mask:0xf bound_ctrl:0
    v_add_f32_dpp v15, v15, v15 row_bcast:31 row_mask:0xc bank_mask:0xf bound_ctrl:0
    v_readlane_b32 s16, v12, 63
    v_readlane_b32 s17, v13, 63
    v_readlane_b32 s18, v14, 63
    v_readlane_b32 s19, v15, 63
    v_mov_b32 v12, s16
    v_mov_b32 v13, s17
    v_mov_b32 v14, s18
    v_mov_b32 v15, s19
    v_cndmask_b32 v12, v12, v14, s[58:59]
    v_cndmask_b32 v13, v13, v15, s[58:59]
    v_mov_b32 v7, 0x3b000000
    v_mul_f32 v13, v7, v13
    v_mul_f32_e64 v6, v13, v13
    v_fma_f32 v12, v12, v7, -v6
    v_max_f32 v12, 0, v12
    v_add_f32 v12, 0x3727c5ac, v12
    v_rsq_f32 v12, v12
    s_lshl_b32 s3, s37, 4
    s_add_u32 s3, s3, 157696
    v_lshl_add_u32 v6, v1, 3, s3
    s_mov_b64 exec, 3
    ds_write_b64 v6, v[12:13]
    s_mov_b64 exec, -1
    s_waitcnt lgkmcnt(0)
    s_add_u32 s66, s66, 1
    s_or_b32 s66, s66, 1
    s_barrier
    v_mov_b32 v12, 158464
    v_mov_b32 v13, 1
    ds_read_b128 v[104:107], v22 offset:16384
    ds_read_b64_tr_b16 v[116:117], v30 offset:0
    ds_read_b64_tr_b16 v[118:119], v30 offset:1024
    ds_read_b64_tr_b16 v[120:121], v31 offset:0
    ds_read_b64_tr_b16 v[122:123], v31 offset:1024
    ds_read_b128 v[108:111], v23 offset:16384
    ds_read_b64_tr_b16 v[124:125], v30 offset:4096
    ds_read_b64_tr_b16 v[126:127], v30 offset:5120
    ds_read_b64_tr_b16 v[128:129], v31 offset:4096
    ds_read_b64_tr_b16 v[130:131], v31 offset:5120
    s_waitcnt lgkmcnt(7)
    v_mfma_f32_32x32x16_bf16 v[40:55], v[116:119], v[104:107], 0
    ds_read_b128 v[112:115], v24 offset:16384
    ds_read_b64_tr_b16 v[132:133], v30 offset:8192
    ds_read_b64_tr_b16 v[134:135], v30 offset:9216
    s_waitcnt lgkmcnt(8)
    v_mfma_f32_32x32x16_bf16 v[56:71], v[120:123], v[104:107], 0
    ds_read_b64_tr_b16 v[136:137], v31 offset:8192
    ds_read_b64_tr_b16 v[138:139], v31 offset:9216
    v_mfma_f32_4x4x4_16b_bf16 v[172:175], v[10:11], v[116:117], 0
    s_nop 1
    v_mfma_f32_4x4x4_16b_bf16 v[172:175], v[10:11], v[118:119], v[172:175]
    s_waitcnt lgkmcnt(7)
    v_mfma_f32_32x32x16_bf16 v[40:55], v[124:127], v[108:111], v[40:55]
    ds_read_b128 v[104:107], v25 offset:16384
    ds_read_b64_tr_b16 v[116:117], v30 offset:12288
    ds_read_b64_tr_b16 v[118:119], v30 offset:13312
    s_waitcnt lgkmcnt(8)
    v_mfma_f32_32x32x16_bf16 v[56:71], v[128:131], v[108:111], v[56:71]
    ds_read_b64_tr_b16 v[120:121], v31 offset:12288
    ds_read_b64_tr_b16 v[122:123], v31 offset:13312
    v_mfma_f32_4x4x4_16b_bf16 v[172:175], v[10:11], v[124:125], v[172:175]
    s_nop 1
    v_mfma_f32_4x4x4_16b_bf16 v[172:175], v[10:11], v[126:127], v[172:175]
    s_waitcnt lgkmcnt(7)
    v_mfma_f32_32x32x16_bf16 v[40:55], v[132:135], v[112:115], v[40:55]
    s_waitcnt lgkmcnt(0)
    s_barrier
    ds_read_b128 v[108:111], v22 offset:32768
    ds_read_b64_tr_b16 v[124:125], v30 offset:16384
    v_mfma_f32_32x32x16_bf16 v[56:71], v[136:139], v[112:115], v[56:71]
    ds_read_b64_tr_b16 v[126:127], v30 offset:17408
    ds_read_b64_tr_b16 v[128:129], v31 offset:16384
    ds_read_b64_tr_b16 v[130:131], v31 offset:17408
    v_mfma_f32_4x4x4_16b_bf16 v[172:175], v[10:11], v[132:133], v[172:175]
    s_nop 1
    v_mfma_f32_4x4x4_16b_bf16 v[172:175], v[10:11], v[134:135], v[172:175]
    v_mfma_f32_32x32x16_bf16 v[40:55], v[116:119], v[104:107], v[40:55]
    ds_read_b128 v[112:115], v23 offset:32768
    ds_read_b64_tr_b16 v[132:133], v30 offset:20480
    ds_read_b64_tr_b16 v[134:135], v30 offset:21504
    v_mfma_f32_32x32x16_bf16 v[56:71], v[120:123], v[104:107], v[56:71]
    ds_read_b64_tr_b16 v[136:137], v31 offset:20480
    ds_read_b64_tr_b16 v[138:139], v31 offset:21504
    v_mfma_f32_4x4x4_16b_bf16 v[172:175], v[10:11], v[116:117], v[172:175]
    s_nop 1
    v_mfma_f32_4x4x4_16b_bf16 v[172:175], v[10:11], v[118:119], v[172:175]
    s_waitcnt lgkmcnt(7)
    v_mfma_f32_32x32x16_bf16 v[40:55], v[124:127], v[108:111], v[40:55]
    ds_read_b128 v[104:107], v24 offset:32768
    ds_read_b64_tr_b16 v[116:117], v30 offset:24576
    ds_read_b64_tr_b16 v[118:119], v30 offset:25600
    ds_read_b64_tr_b16 v[120:121], v31 offset:24576
    s_waitcnt lgkmcnt(9)
    v_mfma_f32_32x32x16_bf16 v[56:71], v[128:131], v[108:111], v[56:71]
    ds_read_b64_tr_b16 v[122:123], v31 offset:25600
    v_cndmask_b32 v172, v172, v173, s[58:59]
    v_cndmask_b32 v174, v174, v175, s[58:59]
    v_cndmask_b32 v173, v172, v174, s[62:63]
    v_cndmask_b32 v172, v172, v174, s[62:63]
    s_waitcnt lgkmcnt(7)
    v_mfma_f32_32x32x16_bf16 v[40:55], v[132:135], v[112:115], v[40:55]
    ds_read_b128 v[108:111], v25 offset:32768
    ds_read_b64_tr_b16 v[124:125], v30 offset:28672
    ds_read_b64_tr_b16 v[126:127], v30 offset:29696
    ds_read_b64_tr_b16 v[128:129], v31 offset:28672
    s_waitcnt lgkmcnt(9)
    v_mfma_f32_32x32x16_bf16 v[56:71], v[136:139], v[112:115], v[56:71]
    ds_read_b64_tr_b16 v[130:131], v31 offset:29696
    v_permlane32_swap_b32 v172, v173
    v_add_f32 v172, v172, v173
    ds_write_b32 v177, v172
    s_waitcnt lgkmcnt(8)
    v_mfma_f32_32x32x16_bf16 v[40:55], v[116:119], v[104:107], v[40:55]
    s_waitcnt lgkmcnt(0)
    s_barrier
    ds_read_b128 v[112:115], v22 offset:40960
    ds_read_b64_tr_b16 v[132:133], v30 offset:32768
    v_mfma_f32_32x32x16_bf16 v[56:71], v[120:123], v[104:107], v[56:71]
    ds_read_b64_tr_b16 v[134:135], v30 offset:33792
    ds_read_b64_tr_b16 v[136:137], v31 offset:32768
    ds_read_b64_tr_b16 v[138:139], v31 offset:33792
    v_mfma_f32_32x32x16_bf16 v[40:55], v[124:127], v[108:111], v[40:55]
    ds_read_b128 v[104:107], v23 offset:40960
    ds_read_b64_tr_b16 v[116:117], v30 offset:36864
    ds_read_b64_tr_b16 v[118:119], v30 offset:37888
    v_mfma_f32_32x32x16_bf16 v[56:71], v[128:131], v[108:111], v[56:71]
    ds_read_b64_tr_b16 v[120:121], v31 offset:36864
    ds_read_b64_tr_b16 v[122:123], v31 offset:37888
    s_waitcnt lgkmcnt(7)
    v_mfma_f32_32x32x16_bf16 v[40:55], v[132:135], v[112:115], v[40:55]
    ds_read_b128 v[108:111], v24 offset:40960
    ds_read_b64_tr_b16 v[124:125], v30 offset:40960
    ds_read_b64_tr_b16 v[126:127], v30 offset:41984
    s_waitcnt lgkmcnt(8)
    v_mfma_f32_32x32x16_bf16 v[56:71], v[136:139], v[112:115], v[56:71]
    ds_read_b64_tr_b16 v[128:129], v31 offset:40960
    ds_read_b64_tr_b16 v[130:131], v31 offset:41984
    s_waitcnt lgkmcnt(7)
    v_mfma_f32_32x32x16_bf16 v[40:55], v[116:119], v[104:107], v[40:55]
    ds_read_b128 v[112:115], v25 offset:40960
    ds_read_b64_tr_b16 v[132:133], v30 offset:45056
    ds_read_b64_tr_b16 v[134:135], v30 offset:46080
    s_waitcnt lgkmcnt(8)
    v_mfma_f32_32x32x16_bf16 v[56:71], v[120:123], v[104:107], v[56:71]
    ds_read_b64_tr_b16 v[136:137], v31 offset:45056
    ds_read_b64_tr_b16 v[138:139], v31 offset:46080
    s_waitcnt lgkmcnt(7)
    v_mfma_f32_32x32x16_bf16 v[40:55], v[124:127], v[108:111], v[40:55]
    s_waitcnt lgkmcnt(0)
    s_barrier
    ds_read_b128 v[104:107], v22 offset:49152
    ds_read_b64_tr_b16 v[116:117], v30 offset:49152
    v_mfma_f32_32x32x16_bf16 v[56:71], v[128:131], v[108:111], v[56:71]
    ds_read_b64_tr_b16 v[118:119], v30 offset:50176
    ds_read_b64_tr_b16 v[120:121], v31 offset:49152
    ds_read_b64_tr_b16 v[122:123], v31 offset:50176
    v_mfma_f32_32x32x16_bf16 v[40:55], v[132:135], v[112:115], v[40:55]
    ds_read_b128 v[108:111], v23 offset:49152
    ds_read_b64_tr_b16 v[124:125], v30 offset:53248
    ds_read_b64_tr_b16 v[126:127], v30 offset:54272
    v_mfma_f32_32x32x16_bf16 v[56:71], v[136:139], v[112:115], v[56:71]
    ds_read_b64_tr_b16 v[128:129], v31 offset:53248
    ds_read_b64_tr_b16 v[130:131], v31 offset:54272
    s_waitcnt lgkmcnt(7)
    v_mfma_f32_32x32x16_bf16 v[40:55], v[116:119], v[104:107], v[40:55]
    ds_read_b128 v[112:115], v24 offset:49152
    ds_read_b64_tr_b16 v[132:133], v30 offset:57344
    ds_read_b64_tr_b16 v[134:135], v30 offset:58368
    s_waitcnt lgkmcnt(8)
    v_mfma_f32_32x32x16_bf16 v[56:71], v[120:123], v[104:107], v[56:71]
    ds_read_b64_tr_b16 v[136:137], v31 offset:57344
    ds_read_b64_tr_b16 v[138:139], v31 offset:58368
    s_waitcnt lgkmcnt(7)
    v_mfma_f32_32x32x16_bf16 v[40:55], v[124:127], v[108:111], v[40:55]
    ds_read_b128 v[104:107], v25 offset:49152
    ds_read_b64_tr_b16 v[116:117], v30 offset:61440
    ds_read_b64_tr_b16 v[118:119], v30 offset:62464
    s_waitcnt lgkmcnt(8)
    v_mfma_f32_32x32x16_bf16 v[56:71], v[128:131], v[108:111], v[56:71]
    ds_read_b64_tr_b16 v[120:121], v31 offset:61440
    ds_read_b64_tr_b16 v[122:123], v31 offset:62464
    s_waitcnt lgkmcnt(7)
    v_mfma_f32_32x32x16_bf16 v[40:55], v[132:135], v[112:115], v[40:55]
    s_waitcnt lgkmcnt(0)
    s_barrier
    ds_read_b128 v[108:111], v26 offset:0
    ds_read_b64_tr_b16 v[124:125], v32 offset:0
    v_mfma_f32_32x32x16_bf16 v[56:71], v[136:139], v[112:115], v[56:71]
    ds_read_b64_tr_b16 v[126:127], v32 offset:1024
    ds_read_b64_tr_b16 v[128:129], v33 offset:0
    ds_read_b64_tr_b16 v[130:131], v33 offset:1024
    v_mfma_f32_32x32x16_bf16 v[40:55], v[116:119], v[104:107], v[40:55]
    ds_read_b128 v[112:115], v27 offset:0
    ds_read_b64_tr_b16 v[132:133], v32 offset:4096
    ds_read_b64_tr_b16 v[134:135], v32 offset:5120
    v_mfma_f32_32x32x16_bf16 v[56:71], v[120:123], v[104:107], v[56:71]
    ds_read_b64_tr_b16 v[136:137], v33 offset:4096
    ds_read_b64_tr_b16 v[138:139], v33 offset:5120
    s_waitcnt lgkmcnt(7)
    v_mfma_f32_32x32x16_bf16 v[40:55], v[124:127], v[108:111], v[40:55]
    ds_read_b128 v[104:107], v28 offset:0
    ds_read_b64_tr_b16 v[116:117], v32 offset:8192
    ds_read_b64_tr_b16 v[118:119], v32 offset:9216
    s_waitcnt lgkmcnt(8)
    v_mfma_f32_32x32x16_bf16 v[56:71], v[128:131], v[108:111], v[56:71]
    ds_read_b64_tr_b16 v[120:121], v33 offset:8192
    ds_read_b64_tr_b16 v[122:123], v33 offset:9216
    s_waitcnt lgkmcnt(7)
    v_mfma_f32_32x32x16_bf16 v[40:55], v[132:135], v[112:115], v[40:55]
    ds_read_b128 v[108:111], v29 offset:0
    ds_read_b64_tr_b16 v[124:125], v32 offset:12288
    ds_read_b64_tr_b16 v[126:127], v32 offset:13312
    s_waitcnt lgkmcnt(8)
    v_mfma_f32_32x32x16_bf16 v[56:71], v[136:139], v[112:115], v[56:71]
    ds_read_b64_tr_b16 v[128:129], v33 offset:12288
    ds_read_b64_tr_b16 v[130:131], v33 offset:13312
    s_waitcnt lgkmcnt(7)
    v_mfma_f32_32x32x16_bf16 v[40:55], v[116:119], v[104:107], v[40:55]
    s_waitcnt lgkmcnt(0)
    s_barrier
    ds_read_b128 v[112:115], v26 offset:8192
    ds_read_b64_tr_b16 v[132:133], v32 offset:16384
    v_mfma_f32_32x32x16_bf16 v[56:71], v[120:123], v[104:107], v[56:71]
    ds_read_b64_tr_b16 v[134:135], v32 offset:17408
    ds_read_b64_tr_b16 v[136:137], v33 offset:16384
    ds_read_b64_tr_b16 v[138:139], v33 offset:17408
    v_mfma_f32_32x32x16_bf16 v[40:55], v[124:127], v[108:111], v[40:55]
    ds_read_b128 v[104:107], v27 offset:8192
    ds_read_b64_tr_b16 v[116:117], v32 offset:20480
    ds_read_b64_tr_b16 v[118:119], v32 offset:21504
    v_mfma_f32_32x32x16_bf16 v[56:71], v[128:131], v[108:111], v[56:71]
    ds_read_b64_tr_b16 v[120:121], v33 offset:20480
    ds_read_b64_tr_b16 v[122:123], v33 offset:21504
    s_waitcnt lgkmcnt(7)
    v_mfma_f32_32x32x16_bf16 v[40:55], v[132:135], v[112:115], v[40:55]
    ds_read_b128 v[108:111], v28 offset:8192
    ds_read_b64_tr_b16 v[124:125], v32 offset:24576
    ds_read_b64_tr_b16 v[126:127], v32 offset:25600
    s_waitcnt lgkmcnt(8)
    v_mfma_f32_32x32x16_bf16 v[56:71], v[136:139], v[112:115], v[56:71]
    ds_read_b64_tr_b16 v[128:129], v33 offset:24576
    ds_read_b64_tr_b16 v[130:131], v33 offset:25600
    s_waitcnt lgkmcnt(7)
    v_mfma_f32_32x32x16_bf16 v[40:55], v[116:119], v[104:107], v[40:55]
    ds_read_b128 v[112:115], v29 offset:8192
    ds_read_b64_tr_b16 v[132:133], v32 offset:28672
    ds_read_b64_tr_b16 v[134:135], v32 offset:29696
    s_waitcnt lgkmcnt(8)
    v_mfma_f32_32x32x16_bf16 v[56:71], v[120:123], v[104:107], v[56:71]
    ds_read_b64_tr_b16 v[136:137], v33 offset:28672
    ds_read_b64_tr_b16 v[138:139], v33 offset:29696
    s_waitcnt lgkmcnt(7)
    v_mfma_f32_32x32x16_bf16 v[40:55], v[124:127], v[108:111], v[40:55]
    s_waitcnt lgkmcnt(0)
    s_barrier
    ds_read_b128 v[104:107], v26 offset:16384
    ds_read_b64_tr_b16 v[116:117], v32 offset:32768
    v_mfma_f32_32x32x16_bf16 v[56:71], v[128:131], v[108:111], v[56:71]
    ds_read_b64_tr_b16 v[118:119], v32 offset:33792
    ds_read_b64_tr_b16 v[120:121], v33 offset:32768
    ds_read_b64_tr_b16 v[122:123], v33 offset:33792
    v_mfma_f32_32x32x16_bf16 v[40:55], v[132:135], v[112:115], v[40:55]
    ds_read_b128 v[108:111], v27 offset:16384
    ds_read_b64_tr_b16 v[124:125], v32 offset:36864
    ds_read_b64_tr_b16 v[126:127], v32 offset:37888
    v_mfma_f32_32x32x16_bf16 v[56:71], v[136:139], v[112:115], v[56:71]
    ds_read_b64_tr_b16 v[128:129], v33 offset:36864
    ds_read_b64_tr_b16 v[130:131], v33 offset:37888
    s_waitcnt lgkmcnt(7)
    v_mfma_f32_32x32x16_bf16 v[40:55], v[116:119], v[104:107], v[40:55]
    ds_read_b128 v[112:115], v28 offset:16384
    ds_read_b64_tr_b16 v[132:133], v32 offset:40960
    ds_read_b64_tr_b16 v[134:135], v32 offset:41984
    s_waitcnt lgkmcnt(8)
    v_mfma_f32_32x32x16_bf16 v[56:71], v[120:123], v[104:107], v[56:71]
    ds_read_b64_tr_b16 v[136:137], v33 offset:40960
    ds_read_b64_tr_b16 v[138:139], v33 offset:41984
    s_waitcnt lgkmcnt(7)
    v_mfma_f32_32x32x16_bf16 v[40:55], v[124:127], v[108:111], v[40:55]
    ds_read_b128 v[104:107], v29 offset:16384
    ds_read_b64_tr_b16 v[116:117], v32 offset:45056
    ds_read_b64_tr_b16 v[118:119], v32 offset:46080
    s_waitcnt lgkmcnt(8)
    v_mfma_f32_32x32x16_bf16 v[56:71], v[128:131], v[108:111], v[56:71]
    ds_read_b64_tr_b16 v[120:121], v33 offset:45056
    ds_read_b64_tr_b16 v[122:123], v33 offset:46080
    s_waitcnt lgkmcnt(7)
    v_mfma_f32_32x32x16_bf16 v[40:55], v[132:135], v[112:115], v[40:55]
    s_waitcnt lgkmcnt(0)
    s_barrier
    ds_read_b128 v[108:111], v26 offset:0
    ds_read_b64_tr_b16 v[124:125], v32 offset:49152
    v_mfma_f32_32x32x16_bf16 v[56:71], v[136:139], v[112:115], v[56:71]
    ds_read_b64_tr_b16 v[126:127], v32 offset:50176
    ds_read_b64_tr_b16 v[128:129], v33 offset:49152
    ds_read_b64_tr_b16 v[130:131], v33 offset:50176
    v_mfma_f32_32x32x16_bf16 v[40:55], v[116:119], v[104:107], v[40:55]
    ds_read_b128 v[112:115], v27 offset:0
    ds_read_b64_tr_b16 v[132:133], v32 offset:53248
    ds_read_b64_tr_b16 v[134:135], v32 offset:54272
    v_mfma_f32_32x32x16_bf16 v[56:71], v[120:123], v[104:107], v[56:71]
    ds_read_b64_tr_b16 v[136:137], v33 offset:53248
    ds_read_b64_tr_b16 v[138:139], v33 offset:54272
    s_waitcnt lgkmcnt(7)
    v_mfma_f32_32x32x16_bf16 v[40:55], v[124:127], v[108:111], v[40:55]
    ds_read_b128 v[104:107], v28 offset:0
    ds_read_b64_tr_b16 v[116:117], v32 offset:57344
    ds_read_b64_tr_b16 v[118:119], v32 offset:58368
    s_waitcnt lgkmcnt(8)
    v_mfma_f32_32x32x16_bf16 v[56:71], v[128:131], v[108:111], v[56:71]
    ds_read_b64_tr_b16 v[120:121], v33 offset:57344
    ds_read_b64_tr_b16 v[122:123], v33 offset:58368
    s_waitcnt lgkmcnt(7)
    v_mfma_f32_32x32x16_bf16 v[40:55], v[132:135], v[112:115], v[40:55]
    ds_read_b128 v[108:111], v29 offset:0
    ds_read_b64_tr_b16 v[124:125], v32 offset:61440
    ds_read_b64_tr_b16 v[126:127], v32 offset:62464
    s_waitcnt lgkmcnt(8)
    v_mfma_f32_32x32x16_bf16 v[56:71], v[136:139], v[112:115], v[56:71]
    ds_read_b64_tr_b16 v[128:129], v33 offset:61440
    ds_read_b64_tr_b16 v[130:131], v33 offset:62464
    s_waitcnt lgkmcnt(7)
    v_mfma_f32_32x32x16_bf16 v[40:55], v[116:119], v[104:107], v[40:55]
    s_waitcnt lgkmcnt(0)
    s_barrier
    ds_read_b128 v[112:115], v26 offset:8192
    ds_read_b64_tr_b16 v[132:133], v30 offset:0
    v_mfma_f32_32x32x16_bf16 v[56:71], v[120:123], v[104:107], v[56:71]
    ds_read_b64_tr_b16 v[134:135], v30 offset:1024
    ds_read_b64_tr_b16 v[136:137], v31 offset:0
    ds_read_b64_tr_b16 v[138:139], v31 offset:1024
    v_mfma_f32_32x32x16_bf16 v[40:55], v[124:127], v[108:111], v[40:55]
    ds_read_b128 v[104:107], v27 offset:8192
    ds_read_b64_tr_b16 v[116:117], v30 offset:4096
    ds_read_b64_tr_b16 v[118:119], v30 offset:5120
    v_mfma_f32_32x32x16_bf16 v[56:71], v[128:131], v[108:111], v[56:71]
    ds_read_b64_tr_b16 v[120:121], v31 offset:4096
    ds_read_b64_tr_b16 v[122:123], v31 offset:5120
    s_waitcnt lgkmcnt(7)
    v_mfma_f32_32x32x16_bf16 v[72:87], v[132:135], v[112:115], 0
    ds_read_b128 v[108:111], v28 offset:8192
    ds_read_b64_tr_b16 v[124:125], v30 offset:8192
    ds_read_b64_tr_b16 v[126:127], v30 offset:9216
    s_waitcnt lgkmcnt(8)
    v_mfma_f32_32x32x16_bf16 v[88:103], v[136:139], v[112:115], 0
    ds_read_b64_tr_b16 v[128:129], v31 offset:8192
    ds_read_b64_tr_b16 v[130:131], v31 offset:9216
    s_waitcnt lgkmcnt(7)
    v_mfma_f32_32x32x16_bf16 v[72:87], v[116:119], v[104:107], v[72:87]
    ds_read_b128 v[112:115], v29 offset:8192
    ds_read_b64_tr_b16 v[132:133], v30 offset:12288
    ds_read_b64_tr_b16 v[134:135], v30 offset:13312
    s_waitcnt lgkmcnt(8)
    v_mfma_f32_32x32x16_bf16 v[88:103], v[120:123], v[104:107], v[88:103]
    ds_read_b64_tr_b16 v[136:137], v31 offset:12288
    ds_read_b64_tr_b16 v[138:139], v31 offset:13312
    s_waitcnt lgkmcnt(7)
    v_mfma_f32_32x32x16_bf16 v[72:87], v[124:127], v[108:111], v[72:87]
    s_waitcnt lgkmcnt(0)
    s_barrier
    ds_read_b128 v[104:107], v26 offset:16384
    ds_read_b64_tr_b16 v[116:117], v30 offset:16384
    v_mfma_f32_32x32x16_bf16 v[88:103], v[128:131], v[108:111], v[88:103]
    ds_read_b64_tr_b16 v[118:119], v30 offset:17408
    ds_read_b64_tr_b16 v[120:121], v31 offset:16384
    ds_read_b64_tr_b16 v[122:123], v31 offset:17408
    v_mfma_f32_32x32x16_bf16 v[72:87], v[132:135], v[112:115], v[72:87]
    ds_read_b128 v[108:111], v27 offset:16384
    ds_read_b64_tr_b16 v[124:125], v30 offset:20480
    ds_read_b64_tr_b16 v[126:127], v30 offset:21504
    ds_read_b64_tr_b16 v[128:129], v31 offset:20480
    ds_read_b64_tr_b16 v[130:131], v31 offset:21504
    ds_read_b64 v[36:37], v176 offset:0
    ds_read_b64 v[38:39], v176 offset:512
    v_mfma_f32_32x32x16_bf16 v[88:103], v[136:139], v[112:115], v[88:103]
    ds_read_b128 v[140:143], v178 offset:0
    ds_read_b128 v[144:147], v178 offset:32
    ds_read_b128 v[148:151], v178 offset:64
    ds_read_b128 v[152:155], v178 offset:96
    ds_read_b128 v[156:159], v179 offset:0
    ds_read_b128 v[160:163], v179 offset:32
    ds_read_b128 v[164:167], v179 offset:64
    ds_read_b128 v[168:171], v179 offset:96
    s_waitcnt lgkmcnt(7)
    v_pk_mul_f32 v[172:173], v[140:141], v[36:37] op_sel:[0,1] op_sel_hi:[1,1]
    v_pk_mul_f32 v[174:175], v[142:143], v[36:37] op_sel:[0,1] op_sel_hi:[1,1]
    s_waitcnt lgkmcnt(6)
    v_pk_mul_f32 v[176:177], v[144:145], v[36:37] op_sel:[0,1] op_sel_hi:[1,1]
    v_pk_mul_f32 v[178:179], v[146:147], v[36:37] op_sel:[0,1] op_sel_hi:[1,1]
    s_waitcnt lgkmcnt(5)
    v_pk_mul_f32 v[180:181], v[148:149], v[36:37] op_sel:[0,1] op_sel_hi:[1,1]
    v_pk_mul_f32 v[182:183], v[150:151], v[36:37] op_sel:[0,1] op_sel_hi:[1,1]
    s_waitcnt lgkmcnt(4)
    v_pk_mul_f32 v[184:185], v[152:153], v[36:37] op_sel:[0,1] op_sel_hi:[1,1]
    v_pk_mul_f32 v[186:187], v[154:155], v[36:37] op_sel:[0,1] op_sel_hi:[1,1]
    v_pk_fma_f32 v[40:41], v[40:41], v[36:37], v[172:173] op_sel:[0,0,0] op_sel_hi:[1,0,1]
    v_pk_fma_f32 v[42:43], v[42:43], v[36:37], v[174:175] op_sel:[0,0,0] op_sel_hi:[1,0,1]
    v_pk_fma_f32 v[44:45], v[44:45], v[36:37], v[176:177] op_sel:[0,0,0] op_sel_hi:[1,0,1]
    v_pk_fma_f32 v[46:47], v[46:47], v[36:37], v[178:179] op_sel:[0,0,0] op_sel_hi:[1,0,1]
    v_pk_fma_f32 v[48:49], v[48:49], v[36:37], v[180:181] op_sel:[0,0,0] op_sel_hi:[1,0,1]
    v_pk_fma_f32 v[50:51], v[50:51], v[36:37], v[182:183] op_sel:[0,0,0] op_sel_hi:[1,0,1]
    v_pk_fma_f32 v[52:53], v[52:53], v[36:37], v[184:185] op_sel:[0,0,0] op_sel_hi:[1,0,1]
    v_pk_fma_f32 v[54:55], v[54:55], v[36:37], v[186:187] op_sel:[0,0,0] op_sel_hi:[1,0,1]
    v_exp_f32 v172, v40
    v_exp_f32 v173, v41
    v_exp_f32 v174, v42
    v_exp_f32 v175, v43
    v_exp_f32 v176, v44
    v_exp_f32 v177, v45
    v_exp_f32 v178, v46
    v_exp_f32 v179, v47
    v_exp_f32 v180, v48
    v_exp_f32 v181, v49
    v_exp_f32 v182, v50
    v_exp_f32 v183, v51
    v_exp_f32 v184, v52
    v_exp_f32 v185, v53
    v_exp_f32 v186, v54
    v_exp_f32_e64 v187, v55
    v_pk_fma_f32 v[172:173], v[172:173], s[60:61], s[60:61]
    v_pk_fma_f32 v[174:175], v[174:175], s[60:61], s[60:61]
    v_pk_fma_f32 v[176:177], v[176:177], s[60:61], s[60:61]
    v_pk_fma_f32 v[178:179], v[178:179], s[60:61], s[60:61]
    v_pk_fma_f32 v[180:181], v[180:181], s[60:61], s[60:61]
    v_pk_fma_f32 v[182:183], v[182:183], s[60:61], s[60:61]
    v_pk_fma_f32 v[184:185], v[184:185], s[60:61], s[60:61]
    v_pk_fma_f32 v[186:187], v[186:187], s[60:61], s[60:61]
    v_rcp_f32 v172, v172
    v_rcp_f32 v173, v173
    v_rcp_f32 v174, v174
    v_rcp_f32 v175, v175
    v_rcp_f32 v176, v176
    v_rcp_f32 v177, v177
    v_rcp_f32 v178, v178
    v_rcp_f32 v179, v179
    v_rcp_f32 v180, v180
    v_rcp_f32 v181, v181
    v_rcp_f32 v182, v182
    v_rcp_f32 v183, v183
    v_rcp_f32 v184, v184
    v_rcp_f32 v185, v185
    v_rcp_f32 v186, v186
    v_rcp_f32 v187, v187
    v_pk_mul_f32 v[172:173], v[40:41], v[172:173]
    v_pk_mul_f32 v[174:175], v[42:43], v[174:175]
    v_pk_mul_f32 v[176:177], v[44:45], v[176:177]
    v_pk_mul_f32 v[178:179], v[46:47], v[178:179]
    v_pk_mul_f32 v[180:181], v[48:49], v[180:181]
    v_pk_mul_f32 v[182:183], v[50:51], v[182:183]
    v_pk_mul_f32 v[184:185], v[52:53], v[184:185]
    v_pk_mul_f32 v[186:187], v[54:55], v[186:187]
    v_cvt_pk_bf16_f32 v40, v172, v173
    v_cvt_pk_bf16_f32 v41, v174, v175
    v_cvt_pk_bf16_f32 v42, v176, v177
    v_cvt_pk_bf16_f32 v43, v178, v179
    buffer_store_dwordx4 v[40:43], v34, s[12:15], s44 offen offset:0 sc1
    v_cvt_pk_bf16_f32 v44, v180, v181
    v_cvt_pk_bf16_f32 v45, v182, v183
    v_cvt_pk_bf16_f32 v46, v184, v185
    v_cvt_pk_bf16_f32 v47, v186, v187
    buffer_store_dwordx4 v[44:47], v34, s[12:15], s44 offen offset:1024 sc1
    s_waitcnt lgkmcnt(3)
    v_pk_mul_f32 v[172:173], v[156:157], v[36:37] op_sel:[0,1] op_sel_hi:[1,1]
    v_pk_mul_f32 v[174:175], v[158:159], v[36:37] op_sel:[0,1] op_sel_hi:[1,1]
    s_waitcnt lgkmcnt(2)
    v_pk_mul_f32 v[176:177], v[160:161], v[36:37] op_sel:[0,1] op_sel_hi:[1,1]
    v_pk_mul_f32 v[178:179], v[162:163], v[36:37] op_sel:[0,1] op_sel_hi:[1,1]
    s_waitcnt lgkmcnt(1)
    v_pk_mul_f32 v[180:181], v[164:165], v[36:37] op_sel:[0,1] op_sel_hi:[1,1]
    v_pk_mul_f32 v[182:183], v[166:167], v[36:37] op_sel:[0,1] op_sel_hi:[1,1]
    s_waitcnt lgkmcnt(0)
    v_pk_mul_f32 v[184:185], v[168:169], v[36:37] op_sel:[0,1] op_sel_hi:[1,1]
    v_pk_mul_f32 v[186:187], v[170:171], v[36:37] op_sel:[0,1] op_sel_hi:[1,1]
    v_pk_fma_f32 v[56:57], v[56:57], v[36:37], v[172:173] op_sel:[0,0,0] op_sel_hi:[1,0,1]
    v_pk_fma_f32 v[58:59], v[58:59], v[36:37], v[174:175] op_sel:[0,0,0] op_sel_hi:[1,0,1]
    v_pk_fma_f32 v[60:61], v[60:61], v[36:37], v[176:177] op_sel:[0,0,0] op_sel_hi:[1,0,1]
    v_pk_fma_f32 v[62:63], v[62:63], v[36:37], v[178:179] op_sel:[0,0,0] op_sel_hi:[1,0,1]
    v_pk_fma_f32 v[64:65], v[64:65], v[36:37], v[180:181] op_sel:[0,0,0] op_sel_hi:[1,0,1]
    v_pk_fma_f32 v[66:67], v[66:67], v[36:37], v[182:183] op_sel:[0,0,0] op_sel_hi:[1,0,1]
    v_pk_fma_f32 v[68:69], v[68:69], v[36:37], v[184:185] op_sel:[0,0,0] op_sel_hi:[1,0,1]
    v_pk_fma_f32 v[70:71], v[70:71], v[36:37], v[186:187] op_sel:[0,0,0] op_sel_hi:[1,0,1]
    v_exp_f32 v172, v56
    v_exp_f32 v173, v57
    v_exp_f32 v174, v58
    v_exp_f32 v175, v59
    v_exp_f32 v176, v60
    v_exp_f32 v177, v61
    v_exp_f32 v178, v62
    v_exp_f32 v179, v63
    v_exp_f32 v180, v64
    v_exp_f32 v181, v65
    v_exp_f32 v182, v66
    v_exp_f32 v183, v67
    v_exp_f32 v184, v68
    v_exp_f32 v185, v69
    v_exp_f32 v186, v70
    v_exp_f32 v187, v71
    v_pk_fma_f32 v[172:173], v[172:173], s[60:61], s[60:61]
    v_pk_fma_f32 v[174:175], v[174:175], s[60:61], s[60:61]
    v_pk_fma_f32 v[176:177], v[176:177], s[60:61], s[60:61]
    v_pk_fma_f32 v[178:179], v[178:179], s[60:61], s[60:61]
    v_pk_fma_f32 v[180:181], v[180:181], s[60:61], s[60:61]
    v_pk_fma_f32 v[182:183], v[182:183], s[60:61], s[60:61]
    v_pk_fma_f32 v[184:185], v[184:185], s[60:61], s[60:61]
    v_pk_fma_f32 v[186:187], v[186:187], s[60:61], s[60:61]
    v_rcp_f32 v172, v172
    v_rcp_f32 v173, v173
    v_rcp_f32 v174, v174
    v_rcp_f32 v175, v175
    v_rcp_f32 v176, v176
    v_rcp_f32 v177, v177
    v_rcp_f32 v178, v178
    v_rcp_f32 v179, v179
    v_rcp_f32 v180, v180
    v_rcp_f32 v181, v181
    v_rcp_f32 v182, v182
    v_rcp_f32 v183, v183
    v_rcp_f32 v184, v184
    v_rcp_f32 v185, v185
    v_rcp_f32 v186, v186
    v_rcp_f32 v187, v187
    v_pk_mul_f32 v[172:173], v[56:57], v[172:173]
    v_pk_mul_f32 v[174:175], v[58:59], v[174:175]
    v_pk_mul_f32 v[176:177], v[60:61], v[176:177]
    v_pk_mul_f32 v[178:179], v[62:63], v[178:179]
    v_pk_mul_f32 v[180:181], v[64:65], v[180:181]
    v_pk_mul_f32 v[182:183], v[66:67], v[182:183]
    v_pk_mul_f32 v[184:185], v[68:69], v[184:185]
    v_pk_mul_f32 v[186:187], v[70:71], v[186:187]
    v_cvt_pk_bf16_f32 v56, v172, v173
    v_cvt_pk_bf16_f32 v57, v174, v175
    v_cvt_pk_bf16_f32 v58, v176, v177
    v_cvt_pk_bf16_f32 v59, v178, v179
    buffer_store_dwordx4 v[56:59], v34, s[12:15], s45 offen offset:0 sc1
    v_cvt_pk_bf16_f32 v60, v180, v181
    v_cvt_pk_bf16_f32 v61, v182, v183
    v_cvt_pk_bf16_f32 v62, v184, v185
    v_cvt_pk_bf16_f32 v63, v186, v187
    buffer_store_dwordx4 v[60:63], v34, s[12:15], s45 offen offset:1024 sc1
    v_mfma_f32_32x32x16_bf16 v[72:87], v[116:119], v[104:107], v[72:87]
    ds_read_b128 v[112:115], v28 offset:16384
    ds_read_b64_tr_b16 v[132:133], v30 offset:24576
    ds_read_b64_tr_b16 v[134:135], v30 offset:25600
    v_mfma_f32_32x32x16_bf16 v[88:103], v[120:123], v[104:107], v[88:103]
    ds_read_b64_tr_b16 v[136:137], v31 offset:24576
    ds_read_b64_tr_b16 v[138:139], v31 offset:25600
    v_mfma_f32_32x32x16_bf16 v[72:87], v[124:127], v[108:111], v[72:87]
    ds_read_b128 v[104:107], v29 offset:16384
    ds_read_b64_tr_b16 v[116:117], v30 offset:28672
    ds_read_b64_tr_b16 v[118:119], v30 offset:29696
    v_mfma_f32_32x32x16_bf16 v[88:103], v[128:131], v[108:111], v[88:103]
    ds_read_b64_tr_b16 v[120:121], v31 offset:28672
    ds_read_b64_tr_b16 v[122:123], v31 offset:29696
    s_waitcnt lgkmcnt(7)
    v_mfma_f32_32x32x16_bf16 v[72:87], v[132:135], v[112:115], v[72:87]
    s_waitcnt lgkmcnt(0)
    s_barrier
    ds_read_b128 v[108:111], v26 offset:0
    ds_read_b64_tr_b16 v[124:125], v30 offset:32768
    v_mfma_f32_32x32x16_bf16 v[88:103], v[136:139], v[112:115], v[88:103]
    ds_read_b64_tr_b16 v[126:127], v30 offset:33792
    ds_read_b64_tr_b16 v[128:129], v31 offset:32768
    ds_read_b64_tr_b16 v[130:131], v31 offset:33792
    v_mfma_f32_32x32x16_bf16 v[72:87], v[116:119], v[104:107], v[72:87]
    ds_read_b128 v[112:115], v27 offset:0
    ds_read_b64_tr_b16 v[132:133], v30 offset:36864
    ds_read_b64_tr_b16 v[134:135], v30 offset:37888
    v_mfma_f32_32x32x16_bf16 v[88:103], v[120:123], v[104:107], v[88:103]
    ds_read_b64_tr_b16 v[136:137], v31 offset:36864
    ds_read_b64_tr_b16 v[138:139], v31 offset:37888
    s_waitcnt lgkmcnt(7)
    v_mfma_f32_32x32x16_bf16 v[72:87], v[124:127], v[108:111], v[72:87]
    ds_read_b128 v[104:107], v28 offset:0
    ds_read_b64_tr_b16 v[116:117], v30 offset:40960
    ds_read_b64_tr_b16 v[118:119], v30 offset:41984
    s_waitcnt lgkmcnt(8)
    v_mfma_f32_32x32x16_bf16 v[88:103], v[128:131], v[108:111], v[88:103]
    ds_read_b64_tr_b16 v[120:121], v31 offset:40960
    ds_read_b64_tr_b16 v[122:123], v31 offset:41984
    s_waitcnt lgkmcnt(7)
    v_mfma_f32_32x32x16_bf16 v[72:87], v[132:135], v[112:115], v[72:87]
    ds_read_b128 v[108:111], v29 offset:0
    ds_read_b64_tr_b16 v[124:125], v30 offset:45056
    ds_read_b64_tr_b16 v[126:127], v30 offset:46080
    s_waitcnt lgkmcnt(8)
    v_mfma_f32_32x32x16_bf16 v[88:103], v[136:139], v[112:115], v[88:103]
    ds_read_b64_tr_b16 v[128:129], v31 offset:45056
    ds_read_b64_tr_b16 v[130:131], v31 offset:46080
    s_waitcnt lgkmcnt(7)
    v_mfma_f32_32x32x16_bf16 v[72:87], v[116:119], v[104:107], v[72:87]
    s_waitcnt lgkmcnt(0)
    s_barrier
    ds_read_b128 v[112:115], v18 offset:0
    ds_read_b64_tr_b16 v[132:133], v30 offset:49152
    v_mfma_f32_32x32x16_bf16 v[88:103], v[120:123], v[104:107], v[88:103]
    ds_read_b64_tr_b16 v[134:135], v30 offset:50176
    ds_read_b64_tr_b16 v[136:137], v31 offset:49152
    ds_read_b64_tr_b16 v[138:139], v31 offset:50176
    v_mfma_f32_32x32x16_bf16 v[72:87], v[124:127], v[108:111], v[72:87]
    ds_read_b128 v[104:107], v19 offset:0
    ds_read_b64_tr_b16 v[116:117], v30 offset:53248
    ds_read_b64_tr_b16 v[118:119], v30 offset:54272
    v_mfma_f32_32x32x16_bf16 v[88:103], v[128:131], v[108:111], v[88:103]
    ds_read_b64_tr_b16 v[120:121], v31 offset:53248
    ds_read_b64_tr_b16 v[122:123], v31 offset:54272
    s_waitcnt lgkmcnt(7)
    v_mfma_f32_32x32x16_bf16 v[72:87], v[132:135], v[112:115], v[72:87]
    ds_read_b128 v[108:111], v20 offset:0
    ds_read_b64_tr_b16 v[124:125], v30 offset:57344
    ds_read_b64_tr_b16 v[126:127], v30 offset:58368
    s_waitcnt lgkmcnt(8)
    v_mfma_f32_32x32x16_bf16 v[88:103], v[136:139], v[112:115], v[88:103]
    ds_read_b64_tr_b16 v[128:129], v31 offset:57344
    ds_read_b64_tr_b16 v[130:131], v31 offset:58368
    s_waitcnt lgkmcnt(7)
    v_mfma_f32_32x32x16_bf16 v[72:87], v[116:119], v[104:107], v[72:87]
    ds_read_b128 v[112:115], v21 offset:0
    ds_read_b64_tr_b16 v[132:133], v30 offset:61440
    ds_read_b64_tr_b16 v[134:135], v30 offset:62464
    s_waitcnt lgkmcnt(8)
    v_mfma_f32_32x32x16_bf16 v[88:103], v[120:123], v[104:107], v[88:103]
    ds_read_b64_tr_b16 v[136:137], v31 offset:61440
    ds_read_b64_tr_b16 v[138:139], v31 offset:62464
    s_waitcnt lgkmcnt(7)
    v_mfma_f32_32x32x16_bf16 v[72:87], v[124:127], v[108:111], v[72:87]
    s_waitcnt lgkmcnt(0)
    s_barrier
    ds_read_b128 v[104:107], v18 offset:8192
    ds_read_b64_tr_b16 v[116:117], v32 offset:0
    v_mfma_f32_32x32x16_bf16 v[88:103], v[128:131], v[108:111], v[88:103]
    ds_read_b64_tr_b16 v[118:119], v32 offset:1024
    ds_read_b64_tr_b16 v[120:121], v33 offset:0
    ds_read_b64_tr_b16 v[122:123], v33 offset:1024
    v_mfma_f32_32x32x16_bf16 v[72:87], v[132:135], v[112:115], v[72:87]
    ds_read_b128 v[108:111], v19 offset:8192
    ds_read_b64_tr_b16 v[124:125], v32 offset:4096
    ds_read_b64_tr_b16 v[126:127], v32 offset:5120
    v_mfma_f32_32x32x16_bf16 v[88:103], v[136:139], v[112:115], v[88:103]
    ds_read_b64_tr_b16 v[128:129], v33 offset:4096
    ds_read_b64_tr_b16 v[130:131], v33 offset:5120
    s_waitcnt lgkmcnt(7)
    v_mfma_f32_32x32x16_bf16 v[72:87], v[116:119], v[104:107], v[72:87]
    ds_read_b128 v[112:115], v20 offset:8192
    ds_read_b64_tr_b16 v[132:133], v32 offset:8192
    ds_read_b64_tr_b16 v[134:135], v32 offset:9216
    s_waitcnt lgkmcnt(8)
    v_mfma_f32_32x32x16_bf16 v[88:103], v[120:123], v[104:107], v[88:103]
    ds_read_b64_tr_b16 v[136:137], v33 offset:8192
    ds_read_b64_tr_b16 v[138:139], v33 offset:9216
    s_waitcnt lgkmcnt(7)
    v_mfma_f32_32x32x16_bf16 v[72:87], v[124:127], v[108:111], v[72:87]
    ds_read_b128 v[104:107], v21 offset:8192
    ds_read_b64_tr_b16 v[116:117], v32 offset:12288
    ds_read_b64_tr_b16 v[118:119], v32 offset:13312
    s_waitcnt lgkmcnt(8)
    v_mfma_f32_32x32x16_bf16 v[88:103], v[128:131], v[108:111], v[88:103]
    ds_read_b64_tr_b16 v[120:121], v33 offset:12288
    ds_read_b64_tr_b16 v[122:123], v33 offset:13312
    s_waitcnt lgkmcnt(7)
    v_mfma_f32_32x32x16_bf16 v[72:87], v[132:135], v[112:115], v[72:87]
    s_waitcnt vmcnt(0) lgkmcnt(0)
    s_barrier
    ds_read_b128 v[108:111], v18 offset:16384
    ds_read_b64_tr_b16 v[124:125], v32 offset:16384
    v_mfma_f32_32x32x16_bf16 v[88:103], v[136:139], v[112:115], v[88:103]
    ds_read_b64_tr_b16 v[126:127], v32 offset:17408
    ds_read_b64_tr_b16 v[128:129], v33 offset:16384
    ds_read_b64_tr_b16 v[130:131], v33 offset:17408
    v_mfma_f32_32x32x16_bf16 v[72:87], v[116:119], v[104:107], v[72:87]
    ds_read_b128 v[112:115], v19 offset:16384
    ds_read_b64_tr_b16 v[132:133], v32 offset:20480
    ds_read_b64_tr_b16 v[134:135], v32 offset:21504
    v_mfma_f32_32x32x16_bf16 v[88:103], v[120:123], v[104:107], v[88:103]
    ds_read_b64_tr_b16 v[136:137], v33 offset:20480
    ds_read_b64_tr_b16 v[138:139], v33 offset:21504
    s_waitcnt lgkmcnt(7)
    v_mfma_f32_32x32x16_bf16 v[72:87], v[124:127], v[108:111], v[72:87]
    ds_read_b128 v[104:107], v20 offset:16384
    ds_read_b64_tr_b16 v[116:117], v32 offset:24576
    ds_read_b64_tr_b16 v[118:119], v32 offset:25600
    s_waitcnt lgkmcnt(8)
    v_mfma_f32_32x32x16_bf16 v[88:103], v[128:131], v[108:111], v[88:103]
    ds_read_b64_tr_b16 v[120:121], v33 offset:24576
    ds_read_b64_tr_b16 v[122:123], v33 offset:25600
    s_waitcnt lgkmcnt(7)
    v_mfma_f32_32x32x16_bf16 v[72:87], v[132:135], v[112:115], v[72:87]
    ds_read_b128 v[108:111], v21 offset:16384
    ds_read_b64_tr_b16 v[124:125], v32 offset:28672
    ds_read_b64_tr_b16 v[126:127], v32 offset:29696
    s_waitcnt lgkmcnt(8)
    v_mfma_f32_32x32x16_bf16 v[88:103], v[136:139], v[112:115], v[88:103]
    ds_read_b64_tr_b16 v[128:129], v33 offset:28672
    ds_read_b64_tr_b16 v[130:131], v33 offset:29696
    s_waitcnt lgkmcnt(7)
    v_mfma_f32_32x32x16_bf16 v[72:87], v[116:119], v[104:107], v[72:87]
    s_waitcnt lgkmcnt(0)
    s_mov_b64 exec, 1
    ds_add_u32 v12, v13
    s_mov_b64 exec, -1
    ds_read_b128 v[112:115], v18 offset:24576
    ds_read_b64_tr_b16 v[132:133], v32 offset:32768
    v_mfma_f32_32x32x16_bf16 v[88:103], v[120:123], v[104:107], v[88:103]
    ds_read_b64_tr_b16 v[134:135], v32 offset:33792
    ds_read_b64_tr_b16 v[136:137], v33 offset:32768
    ds_read_b64_tr_b16 v[138:139], v33 offset:33792
    v_mfma_f32_32x32x16_bf16 v[72:87], v[124:127], v[108:111], v[72:87]
    ds_read_b128 v[104:107], v19 offset:24576
    ds_read_b64_tr_b16 v[116:117], v32 offset:36864
    ds_read_b64_tr_b16 v[118:119], v32 offset:37888
    v_mfma_f32_32x32x16_bf16 v[88:103], v[128:131], v[108:111], v[88:103]
    ds_read_b64_tr_b16 v[120:121], v33 offset:36864
    ds_read_b64_tr_b16 v[122:123], v33 offset:37888
    s_waitcnt lgkmcnt(7)
    v_mfma_f32_32x32x16_bf16 v[72:87], v[132:135], v[112:115], v[72:87]
    ds_read_b128 v[108:111], v20 offset:24576
    ds_read_b64_tr_b16 v[124:125], v32 offset:40960
    ds_read_b64_tr_b16 v[126:127], v32 offset:41984
    s_waitcnt lgkmcnt(8)
    v_mfma_f32_32x32x16_bf16 v[88:103], v[136:139], v[112:115], v[88:103]
    ds_read_b64_tr_b16 v[128:129], v33 offset:40960
    ds_read_b64_tr_b16 v[130:131], v33 offset:41984
    s_waitcnt lgkmcnt(7)
    v_mfma_f32_32x32x16_bf16 v[72:87], v[116:119], v[104:107], v[72:87]
    ds_read_b128 v[112:115], v21 offset:24576
    ds_read_b64_tr_b16 v[132:133], v32 offset:45056
    ds_read_b64_tr_b16 v[134:135], v32 offset:46080
    s_waitcnt lgkmcnt(8)
    v_mfma_f32_32x32x16_bf16 v[88:103], v[120:123], v[104:107], v[88:103]
    ds_read_b64_tr_b16 v[136:137], v33 offset:45056
    ds_read_b64_tr_b16 v[138:139], v33 offset:46080
    s_waitcnt lgkmcnt(7)
    v_mfma_f32_32x32x16_bf16 v[72:87], v[124:127], v[108:111], v[72:87]
    s_waitcnt lgkmcnt(0)
    s_mov_b64 exec, 1
    ds_add_u32 v12, v13
    s_mov_b64 exec, -1
    ds_read_b128 v[104:107], v18 offset:32768
    ds_read_b64_tr_b16 v[116:117], v32 offset:49152
    v_mfma_f32_32x32x16_bf16 v[88:103], v[128:131], v[108:111], v[88:103]
    ds_read_b64_tr_b16 v[118:119], v32 offset:50176
    ds_read_b64_tr_b16 v[120:121], v33 offset:49152
    ds_read_b64_tr_b16 v[122:123], v33 offset:50176
    v_mfma_f32_32x32x16_bf16 v[72:87], v[132:135], v[112:115], v[72:87]
    ds_read_b128 v[108:111], v19 offset:32768
    ds_read_b64_tr_b16 v[124:125], v32 offset:53248
    ds_read_b64_tr_b16 v[126:127], v32 offset:54272
    v_mfma_f32_32x32x16_bf16 v[88:103], v[136:139], v[112:115], v[88:103]
    ds_read_b64_tr_b16 v[128:129], v33 offset:53248
    ds_read_b64_tr_b16 v[130:131], v33 offset:54272
    s_waitcnt lgkmcnt(7)
    v_mfma_f32_32x32x16_bf16 v[72:87], v[116:119], v[104:107], v[72:87]
    ds_read_b128 v[112:115], v20 offset:32768
    ds_read_b64_tr_b16 v[132:133], v32 offset:57344
    ds_read_b64_tr_b16 v[134:135], v32 offset:58368
    s_waitcnt lgkmcnt(8)
    v_mfma_f32_32x32x16_bf16 v[88:103], v[120:123], v[104:107], v[88:103]
    ds_read_b64_tr_b16 v[136:137], v33 offset:57344
    ds_read_b64_tr_b16 v[138:139], v33 offset:58368
    s_waitcnt lgkmcnt(7)
    v_mfma_f32_32x32x16_bf16 v[72:87], v[124:127], v[108:111], v[72:87]
    ds_read_b128 v[104:107], v21 offset:32768
    ds_read_b64_tr_b16 v[116:117], v32 offset:61440
    ds_read_b64_tr_b16 v[118:119], v32 offset:62464
    s_waitcnt lgkmcnt(8)
    v_mfma_f32_32x32x16_bf16 v[88:103], v[128:131], v[108:111], v[88:103]
    ds_read_b64_tr_b16 v[120:121], v33 offset:61440
    ds_read_b64_tr_b16 v[122:123], v33 offset:62464
    s_waitcnt lgkmcnt(7)
    v_mfma_f32_32x32x16_bf16 v[72:87], v[132:135], v[112:115], v[72:87]
    s_waitcnt lgkmcnt(0)
    s_mov_b64 exec, 1
    ds_add_u32 v12, v13
    s_mov_b64 exec, -1
    v_mfma_f32_32x32x16_bf16 v[88:103], v[136:139], v[112:115], v[88:103]
    v_mfma_f32_32x32x16_bf16 v[72:87], v[116:119], v[104:107], v[72:87]
    v_mfma_f32_32x32x16_bf16 v[88:103], v[120:123], v[104:107], v[88:103]
    v_pk_mul_f32 v[172:173], v[140:141], v[38:39] op_sel:[0,1] op_sel_hi:[1,1]
    v_pk_mul_f32 v[174:175], v[142:143], v[38:39] op_sel:[0,1] op_sel_hi:[1,1]
    v_pk_mul_f32 v[176:177], v[144:145], v[38:39] op_sel:[0,1] op_sel_hi:[1,1]
    v_pk_mul_f32 v[178:179], v[146:147], v[38:39] op_sel:[0,1] op_sel_hi:[1,1]
    v_pk_mul_f32 v[180:181], v[148:149], v[38:39] op_sel:[0,1] op_sel_hi:[1,1]
    v_pk_mul_f32 v[182:183], v[150:151], v[38:39] op_sel:[0,1] op_sel_hi:[1,1]
    v_pk_mul_f32 v[184:185], v[152:153], v[38:39] op_sel:[0,1] op_sel_hi:[1,1]
    v_pk_mul_f32 v[186:187], v[154:155], v[38:39] op_sel:[0,1] op_sel_hi:[1,1]
    s_nop 2
    v_pk_fma_f32 v[72:73], v[72:73], v[38:39], v[172:173] op_sel:[0,0,0] op_sel_hi:[1,0,1]
    v_pk_fma_f32 v[74:75], v[74:75], v[38:39], v[174:175] op_sel:[0,0,0] op_sel_hi:[1,0,1]
    v_pk_fma_f32 v[76:77], v[76:77], v[38:39], v[176:177] op_sel:[0,0,0] op_sel_hi:[1,0,1]
    v_pk_fma_f32 v[78:79], v[78:79], v[38:39], v[178:179] op_sel:[0,0,0] op_sel_hi:[1,0,1]
    v_pk_fma_f32 v[80:81], v[80:81], v[38:39], v[180:181] op_sel:[0,0,0] op_sel_hi:[1,0,1]
    v_pk_fma_f32 v[82:83], v[82:83], v[38:39], v[182:183] op_sel:[0,0,0] op_sel_hi:[1,0,1]
    v_pk_fma_f32 v[84:85], v[84:85], v[38:39], v[184:185] op_sel:[0,0,0] op_sel_hi:[1,0,1]
    v_pk_fma_f32 v[86:87], v[86:87], v[38:39], v[186:187] op_sel:[0,0,0] op_sel_hi:[1,0,1]
    v_exp_f32 v172, v72
    v_exp_f32 v173, v73
    v_exp_f32 v174, v74
    v_exp_f32 v175, v75
    v_exp_f32 v176, v76
    v_exp_f32 v177, v77
    v_exp_f32 v178, v78
    v_exp_f32 v179, v79
    v_exp_f32 v180, v80
    v_exp_f32 v181, v81
    v_exp_f32 v182, v82
    v_exp_f32 v183, v83
    v_exp_f32 v184, v84
    v_exp_f32 v185, v85
    v_exp_f32 v186, v86
    v_exp_f32_e64 v187, v87
    v_pk_fma_f32 v[172:173], v[172:173], s[60:61], s[60:61]
    v_pk_fma_f32 v[174:175], v[174:175], s[60:61], s[60:61]
    v_pk_fma_f32 v[176:177], v[176:177], s[60:61], s[60:61]
    v_pk_fma_f32 v[178:179], v[178:179], s[60:61], s[60:61]
    v_pk_fma_f32 v[180:181], v[180:181], s[60:61], s[60:61]
    v_pk_fma_f32 v[182:183], v[182:183], s[60:61], s[60:61]
    v_pk_fma_f32 v[184:185], v[184:185], s[60:61], s[60:61]
    v_pk_fma_f32 v[186:187], v[186:187], s[60:61], s[60:61]
    v_rcp_f32 v172, v172
    v_rcp_f32 v173, v173
    v_rcp_f32 v174, v174
    v_rcp_f32 v175, v175
    v_rcp_f32 v176, v176
    v_rcp_f32 v177, v177
    v_rcp_f32 v178, v178
    v_rcp_f32 v179, v179
    v_rcp_f32 v180, v180
    v_rcp_f32 v181, v181
    v_rcp_f32 v182, v182
    v_rcp_f32 v183, v183
    v_rcp_f32 v184, v184
    v_rcp_f32 v185, v185
    v_rcp_f32 v186, v186
    v_rcp_f32 v187, v187
    v_pk_mul_f32 v[172:173], v[72:73], v[172:173]
    v_pk_mul_f32 v[174:175], v[74:75], v[174:175]
    v_pk_mul_f32 v[176:177], v[76:77], v[176:177]
    v_pk_mul_f32 v[178:179], v[78:79], v[178:179]
    v_pk_mul_f32 v[180:181], v[80:81], v[180:181]
    v_pk_mul_f32 v[182:183], v[82:83], v[182:183]
    v_pk_mul_f32 v[184:185], v[84:85], v[184:185]
    v_pk_mul_f32 v[186:187], v[86:87], v[186:187]
    v_cvt_pk_bf16_f32 v72, v172, v173
    v_cvt_pk_bf16_f32 v73, v174, v175
    v_cvt_pk_bf16_f32 v74, v176, v177
    v_cvt_pk_bf16_f32 v75, v178, v179
    buffer_store_dwordx4 v[72:75], v34, s[12:15], s46 offen offset:0 sc1
    v_cvt_pk_bf16_f32 v76, v180, v181
    v_cvt_pk_bf16_f32 v77, v182, v183
    v_cvt_pk_bf16_f32 v78, v184, v185
    v_cvt_pk_bf16_f32 v79, v186, v187
    buffer_store_dwordx4 v[76:79], v34, s[12:15], s46 offen offset:1024 sc1
    v_pk_mul_f32 v[172:173], v[156:157], v[38:39] op_sel:[0,1] op_sel_hi:[1,1]
    v_pk_mul_f32 v[174:175], v[158:159], v[38:39] op_sel:[0,1] op_sel_hi:[1,1]
    v_pk_mul_f32 v[176:177], v[160:161], v[38:39] op_sel:[0,1] op_sel_hi:[1,1]
    v_pk_mul_f32 v[178:179], v[162:163], v[38:39] op_sel:[0,1] op_sel_hi:[1,1]
    v_pk_mul_f32 v[180:181], v[164:165], v[38:39] op_sel:[0,1] op_sel_hi:[1,1]
    v_pk_mul_f32 v[182:183], v[166:167], v[38:39] op_sel:[0,1] op_sel_hi:[1,1]
    v_pk_mul_f32 v[184:185], v[168:169], v[38:39] op_sel:[0,1] op_sel_hi:[1,1]
    v_pk_mul_f32 v[186:187], v[170:171], v[38:39] op_sel:[0,1] op_sel_hi:[1,1]
    v_pk_fma_f32 v[88:89], v[88:89], v[38:39], v[172:173] op_sel:[0,0,0] op_sel_hi:[1,0,1]
    v_pk_fma_f32 v[90:91], v[90:91], v[38:39], v[174:175] op_sel:[0,0,0] op_sel_hi:[1,0,1]
    v_pk_fma_f32 v[92:93], v[92:93], v[38:39], v[176:177] op_sel:[0,0,0] op_sel_hi:[1,0,1]
    v_pk_fma_f32 v[94:95], v[94:95], v[38:39], v[178:179] op_sel:[0,0,0] op_sel_hi:[1,0,1]
    v_pk_fma_f32 v[96:97], v[96:97], v[38:39], v[180:181] op_sel:[0,0,0] op_sel_hi:[1,0,1]
    v_pk_fma_f32 v[98:99], v[98:99], v[38:39], v[182:183] op_sel:[0,0,0] op_sel_hi:[1,0,1]
    v_pk_fma_f32 v[100:101], v[100:101], v[38:39], v[184:185] op_sel:[0,0,0] op_sel_hi:[1,0,1]
    v_pk_fma_f32 v[102:103], v[102:103], v[38:39], v[186:187] op_sel:[0,0,0] op_sel_hi:[1,0,1]
    v_exp_f32 v172, v88
    v_exp_f32 v173, v89
    v_exp_f32 v174, v90
    v_exp_f32 v175, v91
    v_exp_f32 v176, v92
    v_exp_f32 v177, v93
    v_exp_f32 v178, v94
    v_exp_f32 v179, v95
    v_exp_f32 v180, v96
    v_exp_f32 v181, v97
    v_exp_f32 v182, v98
    v_exp_f32 v183, v99
    v_exp_f32 v184, v100
    v_exp_f32 v185, v101
    v_exp_f32 v186, v102
    v_exp_f32 v187, v103
    v_pk_fma_f32 v[172:173], v[172:173], s[60:61], s[60:61]
    v_pk_fma_f32 v[174:175], v[174:175], s[60:61], s[60:61]
    v_pk_fma_f32 v[176:177], v[176:177], s[60:61], s[60:61]
    v_pk_fma_f32 v[178:179], v[178:179], s[60:61], s[60:61]
    v_pk_fma_f32 v[180:181], v[180:181], s[60:61], s[60:61]
    v_pk_fma_f32 v[182:183], v[182:183], s[60:61], s[60:61]
    v_pk_fma_f32 v[184:185], v[184:185], s[60:61], s[60:61]
    v_pk_fma_f32 v[186:187], v[186:187], s[60:61], s[60:61]
    v_rcp_f32 v172, v172
    v_rcp_f32 v173, v173
    v_rcp_f32 v174, v174
    v_rcp_f32 v175, v175
    v_rcp_f32 v176, v176
    v_rcp_f32 v177, v177
    v_rcp_f32 v178, v178
    v_rcp_f32 v179, v179
    v_rcp_f32 v180, v180
    v_rcp_f32 v181, v181
    v_rcp_f32 v182, v182
    v_rcp_f32 v183, v183
    v_rcp_f32 v184, v184
    v_rcp_f32 v185, v185
    v_rcp_f32 v186, v186
    v_rcp_f32 v187, v187
    v_pk_mul_f32 v[172:173], v[88:89], v[172:173]
    v_pk_mul_f32 v[174:175], v[90:91], v[174:175]
    v_pk_mul_f32 v[176:177], v[92:93], v[176:177]
    v_pk_mul_f32 v[178:179], v[94:95], v[178:179]
    v_pk_mul_f32 v[180:181], v[96:97], v[180:181]
    v_pk_mul_f32 v[182:183], v[98:99], v[182:183]
    v_pk_mul_f32 v[184:185], v[100:101], v[184:185]
    v_pk_mul_f32 v[186:187], v[102:103], v[186:187]
    v_cvt_pk_bf16_f32 v88, v172, v173
    v_cvt_pk_bf16_f32 v89, v174, v175
    v_cvt_pk_bf16_f32 v90, v176, v177
    v_cvt_pk_bf16_f32 v91, v178, v179
    buffer_store_dwordx4 v[88:91], v34, s[12:15], s47 offen offset:0 sc1
    v_cvt_pk_bf16_f32 v92, v180, v181
    v_cvt_pk_bf16_f32 v93, v182, v183
    v_cvt_pk_bf16_f32 v94, v184, v185
    v_cvt_pk_bf16_f32 v95, v186, v187
    buffer_store_dwordx4 v[92:95], v34, s[12:15], s47 offen offset:1024 sc1
    s_branch P2_COMPUTE
K1_DFT:
    v_add_u32 v2, s51, v2
    v_lshlrev_b32 v3, 2, v5
    v_xor_b32 v3, v3, v6
    v_xor_b32_e64 v4, 0, v3
    v_lshl_add_u32 v18, v4, 4, v2
    v_add_u32 v22, 65536, v18
    v_xor_b32 v4, 1, v3
    v_lshl_add_u32 v19, v4, 4, v2
    v_add_u32 v23, 65536, v19
    v_xor_b32 v4, 2, v3
    v_lshl_add_u32 v20, v4, 4, v2
    v_add_u32 v24, 65536, v20
    v_xor_b32_e64 v4, 3, v3
    v_lshl_add_u32 v21, v4, 4, v2
    v_add_u32 v25, 65536, v21
    v_lshlrev_b32 v26, 4, v1
    v_add_u32 v26, 16384, v26
    v_add_u32 v27, 65536, v26
    s_mov_b32 s62, 0x05040100
    s_mov_b32 s63, 0x07060302
    s_lshl_b32 s3, s37, 7
    s_add_u32 s3, s3, 155648
    v_lshl_add_u32 v28, v5, 4, s3
    v_and_b32 v3, 2, v1
    v_cmp_eq_u32 s[48:49], 2, v3
    v_and_b32 v3, 31, v1
    v_lshl_add_u32 v182, v3, 2, s3
    v_lshlrev_b32 v7, 8, v3
    v_and_b32 v3, 7, v1
    v_xor_b32 v3, v3, v5
    s_lshl_b32 s3, s37, 1
    v_xor_b32 v3, s3, v3
    v_lshl_add_u32 v29, v3, 4, v7
    s_mov_b32 s60, 2.0
    s_mov_b32 s61, 2.0
    v_bfe_u32 v3, v1, 2, 1
    v_add_u32 v3, s3, v3
    v_xor_b32 v3, 7, v3
    v_bfe_u32 v4, v1, 3, 1
    v_lshl_add_u32 v3, v3, 1, v4
    v_and_b32 v4, 3, v1
    v_lshl_add_u32 v3, v3, 2, v4
    v_lshlrev_b32 v183, 1, v3
    v_lshrrev_b32 v3, 4, v1
    v_and_b32 v2, 7, v1
    v_xor_b32 v4, v2, v3
    v_lshrrev_b32 v6, 3, v1
    s_lshl_b32 s3, s37, 13
    s_add_u32 s3, s3, 32768
    v_lshl_add_u32 v6, v6, 7, s3
    v_lshl_add_u32 v30, v4, 4, v6
    v_xor_b32 v31, 64, v30
    s_and_b32 s46, s37, 1
    s_lshr_b32 s47, s37, 1
    v_lshlrev_b32 v2, 4, v2
    v_bfe_u32 v4, v1, 3, 1
    v_lshl_add_u32 v2, v4, 12, v2
    s_mul_i32 s3, s46, 3
    v_xor_b32 v4, s3, v3
    v_lshl_add_u32 v32, v4, 13, v2
    s_lshl_b32 s40, s55, 5
    s_lshl_b32 s42, s47, 7
    s_add_u32 s41, s40, s42
    s_sub_u32 s42, 251, s41
    s_cmp_eq_u32 s46, 0
    s_cselect_b32 s41, s41, s42
    s_mov_b32 s43, 0x8000
    s_cselect_b32 s43, s43, 0xffff8000
    s_lshl_b32 s41, s41, 13
    s_lshr_b32 s42, s35, 1
    s_lshl_b32 s42, s42, 11
    s_add_u32 s41, s41, s42
    s_lshl_b32 s42, s34, 9
    s_add_u32 s41, s41, s42
    s_and_b32 s42, s35, 1
    s_lshl_b32 s42, s42, 8
    s_add_u32 s41, s41, s42
    s_add_u32 s41, s41, 7340160
    s_lshl_b32 s42, s47, 6
    s_add_u32 s40, s40, s42
    v_add_u32_e64 v3, s40, v3
    v_cmp_eq_u32 vcc, 99, v3
    v_add_u32 v2, 524288, v32
    s_nop 0
    v_cndmask_b32 v33, v32, v2, vcc
    s_waitcnt vmcnt(2)
    v_dot2_f32_bf16 v12, v80, v80, 0
    v_dot2_f32_bf16 v13, v80, v10, 0
    s_waitcnt vmcnt(1)
    v_dot2_f32_bf16 v14, v84, v84, 0
    v_dot2_f32_bf16 v15, v84, v10, 0
    v_dot2_f32_bf16 v12, v81, v81, v12
    v_dot2_f32_bf16 v13, v81, v10, v13
    v_dot2_f32_bf16 v14, v85, v85, v14
    v_dot2_f32_bf16 v15, v85, v10, v15
    v_dot2_f32_bf16 v12, v82, v82, v12
    v_dot2_f32_bf16 v13, v82, v10, v13
    v_dot2_f32_bf16 v14, v86, v86, v14
    v_dot2_f32_bf16 v15, v86, v10, v15
    v_dot2_f32_bf16 v12, v83, v83, v12
    v_dot2_f32_bf16 v13, v83, v10, v13
    v_dot2_f32_bf16 v14, v87, v87, v14
    v_dot2_f32_bf16 v15, v87, v10, v15
    s_nop 2
    v_add_f32_dpp v12, v12, v12 row_shr:1 row_mask:0xf bank_mask:0xf bound_ctrl:0
    v_add_f32_dpp v13, v13, v13 row_shr:1 row_mask:0xf bank_mask:0xf bound_ctrl:0
    v_add_f32_dpp v14, v14, v14 row_shr:1 row_mask:0xf bank_mask:0xf bound_ctrl:0
    v_add_f32_dpp v15, v15, v15 row_shr:1 row_mask:0xf bank_mask:0xf bound_ctrl:0
    v_add_f32_dpp v12, v12, v12 row_shr:2 row_mask:0xf bank_mask:0xf bound_ctrl:0
    v_add_f32_dpp v13, v13, v13 row_shr:2 row_mask:0xf bank_mask:0xf bound_ctrl:0
    v_add_f32_dpp v14, v14, v14 row_shr:2 row_mask:0xf bank_mask:0xf bound_ctrl:0
    v_add_f32_dpp v15, v15, v15 row_shr:2 row_mask:0xf bank_mask:0xf bound_ctrl:0
    v_add_f32_dpp v12, v12, v12 row_shr:4 row_mask:0xf bank_mask:0xf bound_ctrl:0
    v_add_f32_dpp v13, v13, v13 row_shr:4 row_mask:0xf bank_mask:0xf bound_ctrl:0
    v_add_f32_dpp v14, v14, v14 row_shr:4 row_mask:0xf bank_mask:0xf bound_ctrl:0
    v_add_f32_dpp v15, v15, v15 row_shr:4 row_mask:0xf bank_mask:0xf bound_ctrl:0
    v_add_f32_dpp v12, v12, v12 row_shr:8 row_mask:0xf bank_mask:0xf bound_ctrl:0
    v_add_f32_dpp v13, v13, v13 row_shr:8 row_mask:0xf bank_mask:0xf bound_ctrl:0
    v_add_f32_dpp v14, v14, v14 row_shr:8 row_mask:0xf bank_mask:0xf bound_ctrl:0
    v_add_f32_dpp v15, v15, v15 row_shr:8 row_mask:0xf bank_mask:0xf bound_ctrl:0
    v_add_f32_dpp v12, v12, v12 row_bcast:15 row_mask:0xa bank_mask:0xf bound_ctrl:0
    v_add_f32_dpp v13, v13, v13 row_bcast:15 row_mask:0xa bank_mask:0xf bound_ctrl:0
    v_add_f32_dpp v14, v14, v14 row_bcast:15 row_mask:0xa bank_mask:0xf bound_ctrl:0
    v_add_f32_dpp v15, v15, v15 row_bcast:15 row_mask:0xa bank_mask:0xf bound_ctrl:0
    v_add_f32_dpp v12, v12, v12 row_bcast:31 row_mask:0xc bank_mask:0xf bound_ctrl:0
    v_add_f32_dpp v13, v13, v13 row_bcast:31 row_mask:0xc bank_mask:0xf bound_ctrl:0
    v_add_f32_dpp v14, v14, v14 row_bcast:31 row_mask:0xc bank_mask:0xf bound_ctrl:0
    v_add_f32_dpp v15, v15, v15 row_bcast:31 row_mask:0xc bank_mask:0xf bound_ctrl:0
    v_readlane_b32 s16, v12, 63
    v_readlane_b32 s17, v13, 63
    v_readlane_b32 s18, v14, 63
    v_readlane_b32 s19, v15, 63
    v_mov_b32 v12, s16
    v_mov_b32 v13, s17
    v_mov_b32 v14, s18
    v_mov_b32 v15, s19
    v_cndmask_b32 v12, v12, v14, s[58:59]
    v_cndmask_b32 v13, v13, v15, s[58:59]
    v_mov_b32 v7, 0x3b000000
    v_mul_f32 v13, v7, v13
    v_mul_f32 v6, v13, v13
    v_fma_f32 v12, v12, v7, -v6
    v_max_f32 v12, 0, v12
    v_add_f32 v12, 0x3727c5ac, v12
    v_rsq_f32 v12, v12
    s_lshl_b32 s3, s37, 4
    s_add_u32 s3, s3, 157696
    v_lshl_add_u32 v6, v1, 3, s3
    s_mov_b64 exec, 3
    ds_write_b64 v6, v[12:13]
    s_mov_b64 exec, -1
    s_waitcnt lgkmcnt(0)
    s_add_u32 s66, s66, 1
    s_or_b32 s66, s66, 1
    s_barrier
    ds_read_b128 v[184:187], v18 offset:0
    ds_read_b128 v[188:191], v19 offset:0
    ds_read_b128 v[192:195], v20 offset:0
    ds_read_b128 v[196:199], v21 offset:0
    ds_read_b128 v[216:219], v26 offset:0
    ds_read_b128 v[220:223], v26 offset:1024
    ds_read_b128 v[224:227], v26 offset:2048
    ds_read_b128 v[228:231], v26 offset:3072
    ds_read_b128 v[232:235], v26 offset:4096
    ds_read_b128 v[236:239], v26 offset:5120
    ds_read_b128 v[240:243], v26 offset:6144
    ds_read_b128 v[244:247], v26 offset:7168
    s_waitcnt lgkmcnt(11)
    v_perm_b32 v200, v186, v184, s62
    s_waitcnt lgkmcnt(10)
    v_perm_b32 v201, v190, v188, s62
    s_waitcnt lgkmcnt(9)
    v_perm_b32 v202, v194, v192, s62
    s_waitcnt lgkmcnt(8)
    v_perm_b32 v203, v198, v196, s62
    v_perm_b32 v204, v186, v184, s63
    v_perm_b32 v205, v190, v188, s63
    v_perm_b32 v206, v194, v192, s63
    v_perm_b32 v207, v198, v196, s63
    v_perm_b32 v208, v187, v185, s62
    v_perm_b32 v209, v191, v189, s62
    v_perm_b32 v210, v195, v193, s62
    v_perm_b32 v211, v199, v197, s62
    v_perm_b32 v212, v187, v185, s63
    v_perm_b32 v213, v191, v189, s63
    v_perm_b32 v214, v195, v193, s63
    v_perm_b32 v215, v199, v197, s63
    v_mfma_f32_4x4x4_16b_bf16 v[162:165], v[200:201], v[200:201], 0
    v_mfma_f32_4x4x4_16b_bf16 v[166:169], v[10:11], v[200:201], 0
    s_nop 0
    v_mfma_f32_4x4x4_16b_bf16 v[162:165], v[204:205], v[204:205], v[162:165]
    v_mfma_f32_4x4x4_16b_bf16 v[170:173], v[10:11], v[204:205], 0
    s_nop 0
    v_mfma_f32_4x4x4_16b_bf16 v[162:165], v[208:209], v[208:209], v[162:165]
    v_mfma_f32_4x4x4_16b_bf16 v[174:177], v[10:11], v[208:209], 0
    s_nop 0
    v_mfma_f32_4x4x4_16b_bf16 v[162:165], v[212:213], v[212:213], v[162:165]
    v_mfma_f32_4x4x4_16b_bf16 v[178:181], v[10:11], v[212:213], 0
    s_nop 0
    v_mfma_f32_4x4x4_16b_bf16 v[162:165], v[202:203], v[202:203], v[162:165]
    v_mfma_f32_4x4x4_16b_bf16 v[166:169], v[10:11], v[202:203], v[166:169]
    s_nop 0
    v_mfma_f32_4x4x4_16b_bf16 v[162:165], v[206:207], v[206:207], v[162:165]
    v_mfma_f32_4x4x4_16b_bf16 v[170:173], v[10:11], v[206:207], v[170:173]
    s_nop 0
    v_mfma_f32_4x4x4_16b_bf16 v[162:165], v[210:211], v[210:211], v[162:165]
    v_mfma_f32_4x4x4_16b_bf16 v[174:177], v[10:11], v[210:211], v[174:177]
    s_nop 0
    v_mfma_f32_4x4x4_16b_bf16 v[162:165], v[214:215], v[214:215], v[162:165]
    v_mfma_f32_4x4x4_16b_bf16 v[178:181], v[10:11], v[214:215], v[178:181]
    s_waitcnt lgkmcnt(0)
    s_barrier
    v_mfma_f32_32x32x16_bf16 v[34:49], v[200:203], v[216:219], 0
    ds_read_b128 v[184:187], v18 offset:32768
    ds_read_b128 v[188:191], v19 offset:32768
    ds_read_b128 v[192:195], v20 offset:32768
    ds_read_b128 v[196:199], v21 offset:32768
    v_mfma_f32_32x32x16_bf16 v[50:65], v[200:203], v[220:223], 0
    ds_read_b128 v[216:219], v26 offset:32768
    ds_read_b128 v[220:223], v26 offset:33792
    v_mfma_f32_32x32x16_bf16 v[66:81], v[204:207], v[224:227], 0
    v_mfma_f32_32x32x16_bf16 v[82:97], v[204:207], v[228:231], 0
    ds_read_b128 v[224:227], v26 offset:34816
    ds_read_b128 v[228:231], v26 offset:35840
    s_waitcnt lgkmcnt(7)
    v_perm_b32 v200, v186, v184, s62
    s_waitcnt lgkmcnt(6)
    v_perm_b32 v201, v190, v188, s62
    s_waitcnt lgkmcnt(5)
    v_perm_b32 v202, v194, v192, s62
    s_waitcnt lgkmcnt(4)
    v_perm_b32 v203, v198, v196, s62
    v_mfma_f32_32x32x16_bf16 v[98:113], v[208:211], v[232:235], 0
    v_mfma_f32_32x32x16_bf16 v[114:129], v[208:211], v[236:239], 0
    ds_read_b128 v[232:235], v26 offset:36864
    ds_read_b128 v[236:239], v26 offset:37888
    v_perm_b32 v204, v186, v184, s63
    v_perm_b32 v205, v190, v188, s63
    v_perm_b32 v206, v194, v192, s63
    v_perm_b32 v207, v198, v196, s63
    v_mfma_f32_32x32x16_bf16 v[130:145], v[212:215], v[240:243], 0
    v_mfma_f32_32x32x16_bf16 v[146:161], v[212:215], v[244:247], 0
    ds_read_b128 v[240:243], v26 offset:38912
    ds_read_b128 v[244:247], v26 offset:39936
    v_perm_b32 v208, v187, v185, s62
    v_perm_b32 v209, v191, v189, s62
    v_perm_b32 v210, v195, v193, s62
    v_perm_b32 v211, v199, v197, s62
    v_perm_b32 v212, v187, v185, s63
    v_perm_b32 v213, v191, v189, s63
    v_perm_b32 v214, v195, v193, s63
    v_perm_b32 v215, v199, v197, s63
    v_mfma_f32_4x4x4_16b_bf16 v[162:165], v[200:201], v[200:201], v[162:165]
    v_mfma_f32_4x4x4_16b_bf16 v[166:169], v[10:11], v[200:201], v[166:169]
    s_nop 0
    v_mfma_f32_4x4x4_16b_bf16 v[162:165], v[204:205], v[204:205], v[162:165]
    v_mfma_f32_4x4x4_16b_bf16 v[170:173], v[10:11], v[204:205], v[170:173]
    s_nop 0
    v_mfma_f32_4x4x4_16b_bf16 v[162:165], v[208:209], v[208:209], v[162:165]
    v_mfma_f32_4x4x4_16b_bf16 v[174:177], v[10:11], v[208:209], v[174:177]
    s_nop 0
    v_mfma_f32_4x4x4_16b_bf16 v[162:165], v[212:213], v[212:213], v[162:165]
    v_mfma_f32_4x4x4_16b_bf16 v[178:181], v[10:11], v[212:213], v[178:181]
    s_nop 0
    v_mfma_f32_4x4x4_16b_bf16 v[162:165], v[202:203], v[202:203], v[162:165]
    v_mfma_f32_4x4x4_16b_bf16 v[166:169], v[10:11], v[202:203], v[166:169]
    s_nop 0
    v_mfma_f32_4x4x4_16b_bf16 v[162:165], v[206:207], v[206:207], v[162:165]
    v_mfma_f32_4x4x4_16b_bf16 v[170:173], v[10:11], v[206:207], v[170:173]
    s_nop 0
    v_mfma_f32_4x4x4_16b_bf16 v[162:165], v[210:211], v[210:211], v[162:165]
    v_mfma_f32_4x4x4_16b_bf16 v[174:177], v[10:11], v[210:211], v[174:177]
    s_nop 0
    v_mfma_f32_4x4x4_16b_bf16 v[162:165], v[214:215], v[214:215], v[162:165]
    v_mfma_f32_4x4x4_16b_bf16 v[178:181], v[10:11], v[214:215], v[178:181]
    s_waitcnt lgkmcnt(0)
    s_barrier
    v_mfma_f32_32x32x16_bf16 v[34:49], v[200:203], v[216:219], v[34:49]
    ds_read_b128 v[184:187], v22 offset:0
    ds_read_b128 v[188:191], v23 offset:0
    ds_read_b128 v[192:195], v24 offset:0
    ds_read_b128 v[196:199], v25 offset:0
    v_mfma_f32_32x32x16_bf16 v[50:65], v[200:203], v[220:223], v[50:65]
    ds_read_b128 v[216:219], v27 offset:0
    ds_read_b128 v[220:223], v27 offset:1024
    v_mfma_f32_32x32x16_bf16 v[66:81], v[204:207], v[224:227], v[66:81]
    v_mfma_f32_32x32x16_bf16 v[82:97], v[204:207], v[228:231], v[82:97]
    ds_read_b128 v[224:227], v27 offset:2048
    ds_read_b128 v[228:231], v27 offset:3072
    s_waitcnt lgkmcnt(7)
    v_perm_b32 v200, v186, v184, s62
    s_waitcnt lgkmcnt(6)
    v_perm_b32 v201, v190, v188, s62
    s_waitcnt lgkmcnt(5)
    v_perm_b32 v202, v194, v192, s62
    s_waitcnt lgkmcnt(4)
    v_perm_b32 v203, v198, v196, s62
    v_mfma_f32_32x32x16_bf16 v[98:113], v[208:211], v[232:235], v[98:113]
    v_mfma_f32_32x32x16_bf16 v[114:129], v[208:211], v[236:239], v[114:129]
    ds_read_b128 v[232:235], v27 offset:4096
    ds_read_b128 v[236:239], v27 offset:5120
    v_perm_b32 v204, v186, v184, s63
    v_perm_b32 v205, v190, v188, s63
    v_perm_b32 v206, v194, v192, s63
    v_perm_b32 v207, v198, v196, s63
    v_mfma_f32_32x32x16_bf16 v[130:145], v[212:215], v[240:243], v[130:145]
    v_mfma_f32_32x32x16_bf16 v[146:161], v[212:215], v[244:247], v[146:161]
    ds_read_b128 v[240:243], v27 offset:6144
    ds_read_b128 v[244:247], v27 offset:7168
    v_perm_b32 v208, v187, v185, s62
    v_perm_b32 v209, v191, v189, s62
    v_perm_b32 v210, v195, v193, s62
    v_perm_b32 v211, v199, v197, s62
    v_perm_b32 v212, v187, v185, s63
    v_perm_b32 v213, v191, v189, s63
    v_perm_b32 v214, v195, v193, s63
    v_perm_b32 v215, v199, v197, s63
    v_mfma_f32_4x4x4_16b_bf16 v[162:165], v[200:201], v[200:201], v[162:165]
    v_mfma_f32_4x4x4_16b_bf16 v[166:169], v[10:11], v[200:201], v[166:169]
    s_nop 0
    v_mfma_f32_4x4x4_16b_bf16 v[162:165], v[204:205], v[204:205], v[162:165]
    v_mfma_f32_4x4x4_16b_bf16 v[170:173], v[10:11], v[204:205], v[170:173]
    s_nop 0
    v_mfma_f32_4x4x4_16b_bf16 v[162:165], v[208:209], v[208:209], v[162:165]
    v_mfma_f32_4x4x4_16b_bf16 v[174:177], v[10:11], v[208:209], v[174:177]
    s_nop 0
    v_mfma_f32_4x4x4_16b_bf16 v[162:165], v[212:213], v[212:213], v[162:165]
    v_mfma_f32_4x4x4_16b_bf16 v[178:181], v[10:11], v[212:213], v[178:181]
    s_nop 0
    v_mfma_f32_4x4x4_16b_bf16 v[162:165], v[202:203], v[202:203], v[162:165]
    v_mfma_f32_4x4x4_16b_bf16 v[166:169], v[10:11], v[202:203], v[166:169]
    s_nop 0
    v_mfma_f32_4x4x4_16b_bf16 v[162:165], v[206:207], v[206:207], v[162:165]
    v_mfma_f32_4x4x4_16b_bf16 v[170:173], v[10:11], v[206:207], v[170:173]
    s_nop 0
    v_mfma_f32_4x4x4_16b_bf16 v[162:165], v[210:211], v[210:211], v[162:165]
    v_mfma_f32_4x4x4_16b_bf16 v[174:177], v[10:11], v[210:211], v[174:177]
    s_nop 0
    v_mfma_f32_4x4x4_16b_bf16 v[162:165], v[214:215], v[214:215], v[162:165]
    v_mfma_f32_4x4x4_16b_bf16 v[178:181], v[10:11], v[214:215], v[178:181]
    s_waitcnt lgkmcnt(0)
    s_barrier
    v_mfma_f32_32x32x16_bf16 v[34:49], v[200:203], v[216:219], v[34:49]
    ds_read_b128 v[184:187], v22 offset:32768
    ds_read_b128 v[188:191], v23 offset:32768
    ds_read_b128 v[192:195], v24 offset:32768
    ds_read_b128 v[196:199], v25 offset:32768
    v_mfma_f32_32x32x16_bf16 v[50:65], v[200:203], v[220:223], v[50:65]
    ds_read_b128 v[216:219], v27 offset:32768
    ds_read_b128 v[220:223], v27 offset:33792
    v_mfma_f32_32x32x16_bf16 v[66:81], v[204:207], v[224:227], v[66:81]
    v_mfma_f32_32x32x16_bf16 v[82:97], v[204:207], v[228:231], v[82:97]
    ds_read_b128 v[224:227], v27 offset:34816
    ds_read_b128 v[228:231], v27 offset:35840
    s_waitcnt lgkmcnt(7)
    v_perm_b32 v200, v186, v184, s62
    s_waitcnt lgkmcnt(6)
    v_perm_b32 v201, v190, v188, s62
    s_waitcnt lgkmcnt(5)
    v_perm_b32 v202, v194, v192, s62
    s_waitcnt lgkmcnt(4)
    v_perm_b32 v203, v198, v196, s62
    v_mfma_f32_32x32x16_bf16 v[98:113], v[208:211], v[232:235], v[98:113]
    v_mfma_f32_32x32x16_bf16 v[114:129], v[208:211], v[236:239], v[114:129]
    ds_read_b128 v[232:235], v27 offset:36864
    ds_read_b128 v[236:239], v27 offset:37888
    v_perm_b32 v204, v186, v184, s63
    v_perm_b32 v205, v190, v188, s63
    v_perm_b32 v206, v194, v192, s63
    v_perm_b32 v207, v198, v196, s63
    v_mfma_f32_32x32x16_bf16 v[130:145], v[212:215], v[240:243], v[130:145]
    v_mfma_f32_32x32x16_bf16 v[146:161], v[212:215], v[244:247], v[146:161]
    ds_read_b128 v[240:243], v27 offset:38912
    ds_read_b128 v[244:247], v27 offset:39936
    v_perm_b32 v208, v187, v185, s62
    v_perm_b32 v209, v191, v189, s62
    v_perm_b32 v210, v195, v193, s62
    v_perm_b32 v211, v199, v197, s62
    v_perm_b32 v212, v187, v185, s63
    v_perm_b32 v213, v191, v189, s63
    v_perm_b32 v214, v195, v193, s63
    v_perm_b32 v215, v199, v197, s63
    v_mfma_f32_4x4x4_16b_bf16 v[162:165], v[200:201], v[200:201], v[162:165]
    v_mfma_f32_4x4x4_16b_bf16 v[166:169], v[10:11], v[200:201], v[166:169]
    s_nop 0
    v_mfma_f32_4x4x4_16b_bf16 v[162:165], v[204:205], v[204:205], v[162:165]
    v_mfma_f32_4x4x4_16b_bf16 v[170:173], v[10:11], v[204:205], v[170:173]
    s_nop 0
    v_mfma_f32_4x4x4_16b_bf16 v[162:165], v[208:209], v[208:209], v[162:165]
    v_mfma_f32_4x4x4_16b_bf16 v[174:177], v[10:11], v[208:209], v[174:177]
    s_nop 0
    v_mfma_f32_4x4x4_16b_bf16 v[162:165], v[212:213], v[212:213], v[162:165]
    v_mfma_f32_4x4x4_16b_bf16 v[178:181], v[10:11], v[212:213], v[178:181]
    s_nop 0
    v_mfma_f32_4x4x4_16b_bf16 v[162:165], v[202:203], v[202:203], v[162:165]
    v_mfma_f32_4x4x4_16b_bf16 v[166:169], v[10:11], v[202:203], v[166:169]
    s_nop 0
    v_mfma_f32_4x4x4_16b_bf16 v[162:165], v[206:207], v[206:207], v[162:165]
    v_mfma_f32_4x4x4_16b_bf16 v[170:173], v[10:11], v[206:207], v[170:173]
    s_nop 0
    v_mfma_f32_4x4x4_16b_bf16 v[162:165], v[210:211], v[210:211], v[162:165]
    v_mfma_f32_4x4x4_16b_bf16 v[174:177], v[10:11], v[210:211], v[174:177]
    s_nop 0
    v_mfma_f32_4x4x4_16b_bf16 v[162:165], v[214:215], v[214:215], v[162:165]
    v_mfma_f32_4x4x4_16b_bf16 v[178:181], v[10:11], v[214:215], v[178:181]
    s_waitcnt lgkmcnt(0)
    s_barrier
    v_mfma_f32_32x32x16_bf16 v[34:49], v[200:203], v[216:219], v[34:49]
    ds_read_b128 v[184:187], v18 offset:0
    ds_read_b128 v[188:191], v19 offset:0
    ds_read_b128 v[192:195], v20 offset:0
    ds_read_b128 v[196:199], v21 offset:0
    v_mfma_f32_32x32x16_bf16 v[50:65], v[200:203], v[220:223], v[50:65]
    ds_read_b128 v[216:219], v26 offset:0
    ds_read_b128 v[220:223], v26 offset:1024
    v_mfma_f32_32x32x16_bf16 v[66:81], v[204:207], v[224:227], v[66:81]
    v_mfma_f32_32x32x16_bf16 v[82:97], v[204:207], v[228:231], v[82:97]
    ds_read_b128 v[224:227], v26 offset:2048
    ds_read_b128 v[228:231], v26 offset:3072
    s_waitcnt lgkmcnt(7)
    v_perm_b32 v200, v186, v184, s62
    s_waitcnt lgkmcnt(6)
    v_perm_b32 v201, v190, v188, s62
    s_waitcnt lgkmcnt(5)
    v_perm_b32 v202, v194, v192, s62
    s_waitcnt lgkmcnt(4)
    v_perm_b32 v203, v198, v196, s62
    v_mfma_f32_32x32x16_bf16 v[98:113], v[208:211], v[232:235], v[98:113]
    v_mfma_f32_32x32x16_bf16 v[114:129], v[208:211], v[236:239], v[114:129]
    ds_read_b128 v[232:235], v26 offset:4096
    ds_read_b128 v[236:239], v26 offset:5120
    v_perm_b32 v204, v186, v184, s63
    v_perm_b32 v205, v190, v188, s63
    v_perm_b32 v206, v194, v192, s63
    v_perm_b32 v207, v198, v196, s63
    v_mfma_f32_32x32x16_bf16 v[130:145], v[212:215], v[240:243], v[130:145]
    v_mfma_f32_32x32x16_bf16 v[146:161], v[212:215], v[244:247], v[146:161]
    ds_read_b128 v[240:243], v26 offset:6144
    ds_read_b128 v[244:247], v26 offset:7168
    v_perm_b32 v208, v187, v185, s62
    v_perm_b32 v209, v191, v189, s62
    v_perm_b32 v210, v195, v193, s62
    v_perm_b32 v211, v199, v197, s62
    v_perm_b32 v212, v187, v185, s63
    v_perm_b32 v213, v191, v189, s63
    v_perm_b32 v214, v195, v193, s63
    v_perm_b32 v215, v199, v197, s63
    v_mfma_f32_4x4x4_16b_bf16 v[162:165], v[200:201], v[200:201], v[162:165]
    v_mfma_f32_4x4x4_16b_bf16 v[166:169], v[10:11], v[200:201], v[166:169]
    s_nop 0
    v_mfma_f32_4x4x4_16b_bf16 v[162:165], v[204:205], v[204:205], v[162:165]
    v_mfma_f32_4x4x4_16b_bf16 v[170:173], v[10:11], v[204:205], v[170:173]
    s_nop 0
    v_mfma_f32_4x4x4_16b_bf16 v[162:165], v[208:209], v[208:209], v[162:165]
    v_mfma_f32_4x4x4_16b_bf16 v[174:177], v[10:11], v[208:209], v[174:177]
    s_nop 0
    v_mfma_f32_4x4x4_16b_bf16 v[162:165], v[212:213], v[212:213], v[162:165]
    v_mfma_f32_4x4x4_16b_bf16 v[178:181], v[10:11], v[212:213], v[178:181]
    s_nop 0
    v_mfma_f32_4x4x4_16b_bf16 v[162:165], v[202:203], v[202:203], v[162:165]
    v_mfma_f32_4x4x4_16b_bf16 v[166:169], v[10:11], v[202:203], v[166:169]
    s_nop 0
    v_mfma_f32_4x4x4_16b_bf16 v[162:165], v[206:207], v[206:207], v[162:165]
    v_mfma_f32_4x4x4_16b_bf16 v[170:173], v[10:11], v[206:207], v[170:173]
    s_nop 0
    v_mfma_f32_4x4x4_16b_bf16 v[162:165], v[210:211], v[210:211], v[162:165]
    v_mfma_f32_4x4x4_16b_bf16 v[174:177], v[10:11], v[210:211], v[174:177]
    s_nop 0
    v_mfma_f32_4x4x4_16b_bf16 v[162:165], v[214:215], v[214:215], v[162:165]
    v_mfma_f32_4x4x4_16b_bf16 v[178:181], v[10:11], v[214:215], v[178:181]
    s_waitcnt lgkmcnt(0)
    s_barrier
    v_mfma_f32_32x32x16_bf16 v[34:49], v[200:203], v[216:219], v[34:49]
    ds_read_b128 v[184:187], v18 offset:32768
    ds_read_b128 v[188:191], v19 offset:32768
    ds_read_b128 v[192:195], v20 offset:32768
    ds_read_b128 v[196:199], v21 offset:32768
    v_mfma_f32_32x32x16_bf16 v[50:65], v[200:203], v[220:223], v[50:65]
    ds_read_b128 v[216:219], v26 offset:32768
    ds_read_b128 v[220:223], v26 offset:33792
    v_mfma_f32_32x32x16_bf16 v[66:81], v[204:207], v[224:227], v[66:81]
    v_mfma_f32_32x32x16_bf16 v[82:97], v[204:207], v[228:231], v[82:97]
    ds_read_b128 v[224:227], v26 offset:34816
    ds_read_b128 v[228:231], v26 offset:35840
    s_waitcnt lgkmcnt(7)
    v_perm_b32 v200, v186, v184, s62
    s_waitcnt lgkmcnt(6)
    v_perm_b32 v201, v190, v188, s62
    s_waitcnt lgkmcnt(5)
    v_perm_b32 v202, v194, v192, s62
    s_waitcnt lgkmcnt(4)
    v_perm_b32 v203, v198, v196, s62
    v_mfma_f32_32x32x16_bf16 v[98:113], v[208:211], v[232:235], v[98:113]
    v_mfma_f32_32x32x16_bf16 v[114:129], v[208:211], v[236:239], v[114:129]
    ds_read_b128 v[232:235], v26 offset:36864
    ds_read_b128 v[236:239], v26 offset:37888
    v_perm_b32 v204, v186, v184, s63
    v_perm_b32 v205, v190, v188, s63
    v_perm_b32 v206, v194, v192, s63
    v_perm_b32 v207, v198, v196, s63
    v_mfma_f32_32x32x16_bf16 v[130:145], v[212:215], v[240:243], v[130:145]
    v_mfma_f32_32x32x16_bf16 v[146:161], v[212:215], v[244:247], v[146:161]
    ds_read_b128 v[240:243], v26 offset:38912
    ds_read_b128 v[244:247], v26 offset:39936
    v_perm_b32 v208, v187, v185, s62
    v_perm_b32 v209, v191, v189, s62
    v_perm_b32 v210, v195, v193, s62
    v_perm_b32 v211, v199, v197, s62
    v_perm_b32 v212, v187, v185, s63
    v_perm_b32 v213, v191, v189, s63
    v_perm_b32 v214, v195, v193, s63
    v_perm_b32 v215, v199, v197, s63
    v_mfma_f32_4x4x4_16b_bf16 v[162:165], v[200:201], v[200:201], v[162:165]
    v_mfma_f32_4x4x4_16b_bf16 v[166:169], v[10:11], v[200:201], v[166:169]
    s_nop 0
    v_mfma_f32_4x4x4_16b_bf16 v[162:165], v[204:205], v[204:205], v[162:165]
    v_mfma_f32_4x4x4_16b_bf16 v[170:173], v[10:11], v[204:205], v[170:173]
    s_nop 0
    v_mfma_f32_4x4x4_16b_bf16 v[162:165], v[208:209], v[208:209], v[162:165]
    v_mfma_f32_4x4x4_16b_bf16 v[174:177], v[10:11], v[208:209], v[174:177]
    s_nop 0
    v_mfma_f32_4x4x4_16b_bf16 v[162:165], v[212:213], v[212:213], v[162:165]
    v_mfma_f32_4x4x4_16b_bf16 v[178:181], v[10:11], v[212:213], v[178:181]
    s_nop 0
    v_mfma_f32_4x4x4_16b_bf16 v[162:165], v[202:203], v[202:203], v[162:165]
    v_mfma_f32_4x4x4_16b_bf16 v[166:169], v[10:11], v[202:203], v[166:169]
    s_nop 0
    v_mfma_f32_4x4x4_16b_bf16 v[162:165], v[206:207], v[206:207], v[162:165]
    v_mfma_f32_4x4x4_16b_bf16 v[170:173], v[10:11], v[206:207], v[170:173]
    s_nop 0
    v_mfma_f32_4x4x4_16b_bf16 v[162:165], v[210:211], v[210:211], v[162:165]
    v_mfma_f32_4x4x4_16b_bf16 v[174:177], v[10:11], v[210:211], v[174:177]
    s_nop 0
    v_mfma_f32_4x4x4_16b_bf16 v[162:165], v[214:215], v[214:215], v[162:165]
    v_mfma_f32_4x4x4_16b_bf16 v[178:181], v[10:11], v[214:215], v[178:181]
    s_waitcnt lgkmcnt(0)
    s_barrier
    v_mfma_f32_32x32x16_bf16 v[34:49], v[200:203], v[216:219], v[34:49]
    ds_read_b128 v[184:187], v22 offset:0
    ds_read_b128 v[188:191], v23 offset:0
    ds_read_b128 v[192:195], v24 offset:0
    ds_read_b128 v[196:199], v25 offset:0
    v_mfma_f32_32x32x16_bf16 v[50:65], v[200:203], v[220:223], v[50:65]
    ds_read_b128 v[216:219], v27 offset:0
    ds_read_b128 v[220:223], v27 offset:1024
    v_mfma_f32_32x32x16_bf16 v[66:81], v[204:207], v[224:227], v[66:81]
    v_mfma_f32_32x32x16_bf16 v[82:97], v[204:207], v[228:231], v[82:97]
    ds_read_b128 v[224:227], v27 offset:2048
    ds_read_b128 v[228:231], v27 offset:3072
    s_waitcnt lgkmcnt(7)
    v_perm_b32 v200, v186, v184, s62
    s_waitcnt lgkmcnt(6)
    v_perm_b32 v201, v190, v188, s62
    s_waitcnt lgkmcnt(5)
    v_perm_b32 v202, v194, v192, s62
    s_waitcnt lgkmcnt(4)
    v_perm_b32 v203, v198, v196, s62
    v_mfma_f32_32x32x16_bf16 v[98:113], v[208:211], v[232:235], v[98:113]
    v_mfma_f32_32x32x16_bf16 v[114:129], v[208:211], v[236:239], v[114:129]
    ds_read_b128 v[232:235], v27 offset:4096
    ds_read_b128 v[236:239], v27 offset:5120
    v_perm_b32 v204, v186, v184, s63
    v_perm_b32 v205, v190, v188, s63
    v_perm_b32 v206, v194, v192, s63
    v_perm_b32 v207, v198, v196, s63
    v_mfma_f32_32x32x16_bf16 v[130:145], v[212:215], v[240:243], v[130:145]
    v_mfma_f32_32x32x16_bf16 v[146:161], v[212:215], v[244:247], v[146:161]
    ds_read_b128 v[240:243], v27 offset:6144
    ds_read_b128 v[244:247], v27 offset:7168
    v_perm_b32 v208, v187, v185, s62
    v_perm_b32 v209, v191, v189, s62
    v_perm_b32 v210, v195, v193, s62
    v_perm_b32 v211, v199, v197, s62
    v_perm_b32 v212, v187, v185, s63
    v_perm_b32 v213, v191, v189, s63
    v_perm_b32 v214, v195, v193, s63
    v_perm_b32 v215, v199, v197, s63
    v_mfma_f32_4x4x4_16b_bf16 v[162:165], v[200:201], v[200:201], v[162:165]
    v_mfma_f32_4x4x4_16b_bf16 v[166:169], v[10:11], v[200:201], v[166:169]
    s_nop 0
    v_mfma_f32_4x4x4_16b_bf16 v[162:165], v[204:205], v[204:205], v[162:165]
    v_mfma_f32_4x4x4_16b_bf16 v[170:173], v[10:11], v[204:205], v[170:173]
    s_nop 0
    v_mfma_f32_4x4x4_16b_bf16 v[162:165], v[208:209], v[208:209], v[162:165]
    v_mfma_f32_4x4x4_16b_bf16 v[174:177], v[10:11], v[208:209], v[174:177]
    s_nop 0
    v_mfma_f32_4x4x4_16b_bf16 v[162:165], v[212:213], v[212:213], v[162:165]
    v_mfma_f32_4x4x4_16b_bf16 v[178:181], v[10:11], v[212:213], v[178:181]
    s_nop 0
    v_mfma_f32_4x4x4_16b_bf16 v[162:165], v[202:203], v[202:203], v[162:165]
    v_mfma_f32_4x4x4_16b_bf16 v[166:169], v[10:11], v[202:203], v[166:169]
    s_nop 0
    v_mfma_f32_4x4x4_16b_bf16 v[162:165], v[206:207], v[206:207], v[162:165]
    v_mfma_f32_4x4x4_16b_bf16 v[170:173], v[10:11], v[206:207], v[170:173]
    s_nop 0
    v_mfma_f32_4x4x4_16b_bf16 v[162:165], v[210:211], v[210:211], v[162:165]
    v_mfma_f32_4x4x4_16b_bf16 v[174:177], v[10:11], v[210:211], v[174:177]
    s_nop 0
    v_mfma_f32_4x4x4_16b_bf16 v[162:165], v[214:215], v[214:215], v[162:165]
    v_mfma_f32_4x4x4_16b_bf16 v[178:181], v[10:11], v[214:215], v[178:181]
    s_waitcnt lgkmcnt(0)
    s_barrier
    v_mfma_f32_32x32x16_bf16 v[34:49], v[200:203], v[216:219], v[34:49]
    ds_read_b128 v[184:187], v22 offset:32768
    ds_read_b128 v[188:191], v23 offset:32768
    ds_read_b128 v[192:195], v24 offset:32768
    ds_read_b128 v[196:199], v25 offset:32768
    v_mfma_f32_32x32x16_bf16 v[50:65], v[200:203], v[220:223], v[50:65]
    ds_read_b128 v[216:219], v27 offset:32768
    ds_read_b128 v[220:223], v27 offset:33792
    v_mfma_f32_32x32x16_bf16 v[66:81], v[204:207], v[224:227], v[66:81]
    v_mfma_f32_32x32x16_bf16 v[82:97], v[204:207], v[228:231], v[82:97]
    ds_read_b128 v[224:227], v27 offset:34816
    ds_read_b128 v[228:231], v27 offset:35840
    s_waitcnt lgkmcnt(7)
    v_perm_b32 v200, v186, v184, s62
    s_waitcnt lgkmcnt(6)
    v_perm_b32 v201, v190, v188, s62
    s_waitcnt lgkmcnt(5)
    v_perm_b32 v202, v194, v192, s62
    s_waitcnt lgkmcnt(4)
    v_perm_b32 v203, v198, v196, s62
    v_mfma_f32_32x32x16_bf16 v[98:113], v[208:211], v[232:235], v[98:113]
    v_mfma_f32_32x32x16_bf16 v[114:129], v[208:211], v[236:239], v[114:129]
    ds_read_b128 v[232:235], v27 offset:36864
    ds_read_b128 v[236:239], v27 offset:37888
    v_perm_b32 v204, v186, v184, s63
    v_perm_b32 v205, v190, v188, s63
    v_perm_b32 v206, v194, v192, s63
    v_perm_b32 v207, v198, v196, s63
    v_mfma_f32_32x32x16_bf16 v[130:145], v[212:215], v[240:243], v[130:145]
    v_mfma_f32_32x32x16_bf16 v[146:161], v[212:215], v[244:247], v[146:161]
    ds_read_b128 v[240:243], v27 offset:38912
    ds_read_b128 v[244:247], v27 offset:39936
    v_perm_b32 v208, v187, v185, s62
    v_perm_b32 v209, v191, v189, s62
    v_perm_b32 v210, v195, v193, s62
    v_perm_b32 v211, v199, v197, s62
    v_perm_b32 v212, v187, v185, s63
    v_perm_b32 v213, v191, v189, s63
    v_perm_b32 v214, v195, v193, s63
    v_perm_b32 v215, v199, v197, s63
    v_mfma_f32_4x4x4_16b_bf16 v[162:165], v[200:201], v[200:201], v[162:165]
    v_mfma_f32_4x4x4_16b_bf16 v[166:169], v[10:11], v[200:201], v[166:169]
    s_nop 0
    v_mfma_f32_4x4x4_16b_bf16 v[162:165], v[204:205], v[204:205], v[162:165]
    v_mfma_f32_4x4x4_16b_bf16 v[170:173], v[10:11], v[204:205], v[170:173]
    s_nop 0
    v_mfma_f32_4x4x4_16b_bf16 v[162:165], v[208:209], v[208:209], v[162:165]
    v_mfma_f32_4x4x4_16b_bf16 v[174:177], v[10:11], v[208:209], v[174:177]
    s_nop 0
    v_mfma_f32_4x4x4_16b_bf16 v[162:165], v[212:213], v[212:213], v[162:165]
    v_mfma_f32_4x4x4_16b_bf16 v[178:181], v[10:11], v[212:213], v[178:181]
    s_nop 0
    v_mfma_f32_4x4x4_16b_bf16 v[162:165], v[202:203], v[202:203], v[162:165]
    v_mfma_f32_4x4x4_16b_bf16 v[166:169], v[10:11], v[202:203], v[166:169]
    s_nop 0
    v_mfma_f32_4x4x4_16b_bf16 v[162:165], v[206:207], v[206:207], v[162:165]
    v_mfma_f32_4x4x4_16b_bf16 v[170:173], v[10:11], v[206:207], v[170:173]
    s_nop 0
    v_mfma_f32_4x4x4_16b_bf16 v[162:165], v[210:211], v[210:211], v[162:165]
    v_mfma_f32_4x4x4_16b_bf16 v[174:177], v[10:11], v[210:211], v[174:177]
    s_nop 0
    v_mfma_f32_4x4x4_16b_bf16 v[162:165], v[214:215], v[214:215], v[162:165]
    v_mfma_f32_4x4x4_16b_bf16 v[178:181], v[10:11], v[214:215], v[178:181]
    s_waitcnt lgkmcnt(7)
    v_mfma_f32_32x32x16_bf16 v[34:49], v[200:203], v[216:219], v[34:49]
    s_nop 1
    v_cndmask_b32 v162, v162, v163, s[58:59]
    v_cndmask_b32 v164, v164, v165, s[58:59]
    v_cndmask_b32 v166, v166, v167, s[58:59]
    v_cndmask_b32 v168, v168, v169, s[58:59]
    v_cndmask_b32 v170, v170, v171, s[58:59]
    v_cndmask_b32 v172, v172, v173, s[58:59]
    s_waitcnt lgkmcnt(6)
    v_mfma_f32_32x32x16_bf16 v[50:65], v[200:203], v[220:223], v[50:65]
    v_cndmask_b32 v174, v174, v175, s[58:59]
    v_cndmask_b32 v176, v176, v177, s[58:59]
    v_cndmask_b32 v178, v178, v179, s[58:59]
    v_cndmask_b32 v180, v180, v181, s[58:59]
    v_cndmask_b32 v163, v162, v164, s[48:49]
    v_cndmask_b32 v162, v162, v164, s[48:49]
    s_waitcnt lgkmcnt(5)
    v_mfma_f32_32x32x16_bf16 v[66:81], v[204:207], v[224:227], v[66:81]
    v_cndmask_b32 v167, v166, v168, s[48:49]
    v_cndmask_b32 v166, v166, v168, s[48:49]
    v_cndmask_b32 v171, v170, v172, s[48:49]
    v_cndmask_b32 v170, v170, v172, s[48:49]
    v_cndmask_b32 v175, v174, v176, s[48:49]
    v_cndmask_b32 v174, v174, v176, s[48:49]
    s_waitcnt lgkmcnt(4)
    v_mfma_f32_32x32x16_bf16 v[82:97], v[204:207], v[228:231], v[82:97]
    v_cndmask_b32 v179, v178, v180, s[48:49]
    v_cndmask_b32 v178, v178, v180, s[48:49]
    v_permlane32_swap_b32 v162, v163
    v_permlane32_swap_b32 v166, v167
    v_permlane32_swap_b32 v170, v171
    v_permlane32_swap_b32 v174, v175
    s_waitcnt lgkmcnt(3)
    v_mfma_f32_32x32x16_bf16 v[98:113], v[208:211], v[232:235], v[98:113]
    v_permlane32_swap_b32 v178, v179
    v_add_f32 v166, v166, v167
    v_add_f32 v170, v170, v171
    v_add_f32 v174, v174, v175
    v_add_f32 v178, v178, v179
    v_add_f32 v2, v162, v163
    s_waitcnt lgkmcnt(2)
    v_mfma_f32_32x32x16_bf16 v[114:129], v[208:211], v[236:239], v[114:129]
    v_add_f32 v162, v166, v174
    v_add_f32 v163, v170, v178
    v_add_f32 v3, v162, v163
    v_mov_b32 v7, 0x3b000000
    v_mul_f32 v3, v7, v3
    v_mul_f32 v6, v3, v3
    s_waitcnt lgkmcnt(1)
    v_mfma_f32_32x32x16_bf16 v[130:145], v[212:215], v[240:243], v[130:145]
    v_fma_f32 v2, v2, v7, -v6
    v_max_f32 v2, 0, v2
    v_add_f32 v2, 0x3727c5ac, v2
    v_rsq_f32 v2, v2
    ds_write_b32 v182, v2
    s_waitcnt lgkmcnt(0)
    v_mfma_f32_32x32x16_bf16 v[146:161], v[212:215], v[244:247], v[146:161]
    ds_read_b128 v[184:187], v28 offset:0
    ds_read_b128 v[188:191], v28 offset:32
    ds_read_b128 v[192:195], v28 offset:64
    ds_read_b128 v[196:199], v28 offset:96
    v_sub_f32 v162, v162, v163
    v_sub_f32 v163, v166, v174
    v_sub_f32 v164, v178, v170
    v_mul_f32 v162, v162, v2
    v_mul_f32 v163, v163, v2
    v_mul_f32 v164, v164, v2
    v_cvt_pk_bf16_f32 v162, v162, 0
    v_cvt_pk_bf16_f32 v163, v163, v164
    s_waitcnt lgkmcnt(3)
    v_pk_mul_f32 v[200:201], v[34:35], v[184:185]
    v_pk_mul_f32 v[202:203], v[50:51], v[184:185]
    v_pk_mul_f32 v[204:205], v[66:67], v[184:185]
    v_pk_mul_f32 v[206:207], v[82:83], v[184:185]
    v_pk_fma_f32 v[34:35], v[98:99], v[184:185], v[200:201]
    v_pk_fma_f32 v[98:99], v[98:99], v[184:185], v[200:201] neg_lo:[1,0,0] neg_hi:[1,0,0]
    v_pk_fma_f32 v[50:51], v[114:115], v[184:185], v[202:203]
    v_pk_fma_f32 v[114:115], v[114:115], v[184:185], v[202:203] neg_lo:[1,0,0] neg_hi:[1,0,0]
    v_pk_fma_f32 v[66:67], v[130:131], v[184:185], v[204:205]
    v_pk_fma_f32 v[130:131], v[130:131], v[184:185], v[204:205] neg_lo:[1,0,0] neg_hi:[1,0,0]
    v_pk_fma_f32 v[82:83], v[146:147], v[184:185], v[206:207]
    v_pk_fma_f32 v[146:147], v[146:147], v[184:185], v[206:207] neg_lo:[1,0,0] neg_hi:[1,0,0]
    v_pk_add_f32 v[34:35], v[34:35], v[66:67]
    v_pk_add_f32 v[50:51], v[50:51], v[82:83]
    v_pk_add_f32 v[98:99], v[98:99], v[146:147]
    v_pk_add_f32 v[114:115], v[114:115], v[130:131] neg_lo:[0,1] neg_hi:[0,1]
    v_pk_fma_f32 v[66:67], v[66:67], s[60:61], v[34:35] neg_lo:[1,0,0] neg_hi:[1,0,0]
    v_pk_fma_f32 v[82:83], v[82:83], s[60:61], v[50:51] neg_lo:[0,0,1] neg_hi:[0,0,1]
    v_pk_fma_f32 v[146:147], v[146:147], s[60:61], v[98:99] neg_lo:[1,0,0] neg_hi:[1,0,0]
    v_pk_fma_f32 v[130:131], v[130:131], s[60:61], v[114:115] neg_lo:[1,0,1] neg_hi:[1,0,1]
    v_pk_mul_f32 v[200:201], v[36:37], v[186:187]
    v_pk_mul_f32 v[202:203], v[52:53], v[186:187]
    v_pk_mul_f32 v[204:205], v[68:69], v[186:187]
    v_pk_mul_f32 v[206:207], v[84:85], v[186:187]
    v_pk_fma_f32 v[36:37], v[100:101], v[186:187], v[200:201]
    v_pk_fma_f32 v[100:101], v[100:101], v[186:187], v[200:201] neg_lo:[1,0,0] neg_hi:[1,0,0]
    v_pk_fma_f32 v[52:53], v[116:117], v[186:187], v[202:203]
    v_pk_fma_f32 v[116:117], v[116:117], v[186:187], v[202:203] neg_lo:[1,0,0] neg_hi:[1,0,0]
    v_pk_fma_f32 v[68:69], v[132:133], v[186:187], v[204:205]
    v_pk_fma_f32 v[132:133], v[132:133], v[186:187], v[204:205] neg_lo:[1,0,0] neg_hi:[1,0,0]
    v_pk_fma_f32 v[84:85], v[148:149], v[186:187], v[206:207]
    v_pk_fma_f32 v[148:149], v[148:149], v[186:187], v[206:207] neg_lo:[1,0,0] neg_hi:[1,0,0]
    v_pk_add_f32 v[36:37], v[36:37], v[68:69]
    v_pk_add_f32 v[52:53], v[52:53], v[84:85]
    v_pk_add_f32 v[100:101], v[100:101], v[148:149]
    v_pk_add_f32 v[116:117], v[116:117], v[132:133] neg_lo:[0,1] neg_hi:[0,1]
    v_pk_fma_f32 v[68:69], v[68:69], s[60:61], v[36:37] neg_lo:[1,0,0] neg_hi:[1,0,0]
    v_pk_fma_f32 v[84:85], v[84:85], s[60:61], v[52:53] neg_lo:[0,0,1] neg_hi:[0,0,1]
    v_pk_fma_f32 v[148:149], v[148:149], s[60:61], v[100:101] neg_lo:[1,0,0] neg_hi:[1,0,0]
    v_pk_fma_f32 v[132:133], v[132:133], s[60:61], v[116:117] neg_lo:[1,0,1] neg_hi:[1,0,1]
    s_waitcnt lgkmcnt(2)
    v_pk_mul_f32 v[200:201], v[38:39], v[188:189]
    v_pk_mul_f32 v[202:203], v[54:55], v[188:189]
    v_pk_mul_f32 v[204:205], v[70:71], v[188:189]
    v_pk_mul_f32 v[206:207], v[86:87], v[188:189]
    v_pk_fma_f32 v[38:39], v[102:103], v[188:189], v[200:201]
    v_pk_fma_f32 v[102:103], v[102:103], v[188:189], v[200:201] neg_lo:[1,0,0] neg_hi:[1,0,0]
    v_pk_fma_f32 v[54:55], v[118:119], v[188:189], v[202:203]
    v_pk_fma_f32 v[118:119], v[118:119], v[188:189], v[202:203] neg_lo:[1,0,0] neg_hi:[1,0,0]
    v_pk_fma_f32 v[70:71], v[134:135], v[188:189], v[204:205]
    v_pk_fma_f32 v[134:135], v[134:135], v[188:189], v[204:205] neg_lo:[1,0,0] neg_hi:[1,0,0]
    v_pk_fma_f32 v[86:87], v[150:151], v[188:189], v[206:207]
    v_pk_fma_f32 v[150:151], v[150:151], v[188:189], v[206:207] neg_lo:[1,0,0] neg_hi:[1,0,0]
    v_pk_add_f32 v[38:39], v[38:39], v[70:71]
    v_pk_add_f32 v[54:55], v[54:55], v[86:87]
    v_pk_add_f32 v[102:103], v[102:103], v[150:151]
    v_pk_add_f32 v[118:119], v[118:119], v[134:135] neg_lo:[0,1] neg_hi:[0,1]
    v_pk_fma_f32 v[70:71], v[70:71], s[60:61], v[38:39] neg_lo:[1,0,0] neg_hi:[1,0,0]
    v_pk_fma_f32 v[86:87], v[86:87], s[60:61], v[54:55] neg_lo:[0,0,1] neg_hi:[0,0,1]
    v_pk_fma_f32 v[150:151], v[150:151], s[60:61], v[102:103] neg_lo:[1,0,0] neg_hi:[1,0,0]
    v_pk_fma_f32 v[134:135], v[134:135], s[60:61], v[118:119] neg_lo:[1,0,1] neg_hi:[1,0,1]
    v_pk_mul_f32 v[200:201], v[40:41], v[190:191]
    v_pk_mul_f32 v[202:203], v[56:57], v[190:191]
    v_pk_mul_f32 v[204:205], v[72:73], v[190:191]
    v_pk_mul_f32 v[206:207], v[88:89], v[190:191]
    v_pk_fma_f32 v[40:41], v[104:105], v[190:191], v[200:201]
    v_pk_fma_f32 v[104:105], v[104:105], v[190:191], v[200:201] neg_lo:[1,0,0] neg_hi:[1,0,0]
    v_pk_fma_f32 v[56:57], v[120:121], v[190:191], v[202:203]
    v_pk_fma_f32 v[120:121], v[120:121], v[190:191], v[202:203] neg_lo:[1,0,0] neg_hi:[1,0,0]
    v_pk_fma_f32 v[72:73], v[136:137], v[190:191], v[204:205]
    v_pk_fma_f32 v[136:137], v[136:137], v[190:191], v[204:205] neg_lo:[1,0,0] neg_hi:[1,0,0]
    v_pk_fma_f32 v[88:89], v[152:153], v[190:191], v[206:207]
    v_pk_fma_f32 v[152:153], v[152:153], v[190:191], v[206:207] neg_lo:[1,0,0] neg_hi:[1,0,0]
    v_pk_add_f32 v[40:41], v[40:41], v[72:73]
    v_pk_add_f32 v[56:57], v[56:57], v[88:89]
    v_pk_add_f32 v[104:105], v[104:105], v[152:153]
    v_pk_add_f32 v[120:121], v[120:121], v[136:137] neg_lo:[0,1] neg_hi:[0,1]
    v_pk_fma_f32 v[72:73], v[72:73], s[60:61], v[40:41] neg_lo:[1,0,0] neg_hi:[1,0,0]
    v_pk_fma_f32 v[88:89], v[88:89], s[60:61], v[56:57] neg_lo:[0,0,1] neg_hi:[0,0,1]
    v_pk_fma_f32 v[152:153], v[152:153], s[60:61], v[104:105] neg_lo:[1,0,0] neg_hi:[1,0,0]
    v_pk_fma_f32 v[136:137], v[136:137], s[60:61], v[120:121] neg_lo:[1,0,1] neg_hi:[1,0,1]
    v_cvt_pk_bf16_f32 v216, v34, v35
    v_cvt_pk_bf16_f32 v217, v36, v37
    v_cvt_pk_bf16_f32 v218, v38, v39
    v_cvt_pk_bf16_f32 v219, v40, v41
    ds_write_b128 v29, v[216:219] offset:0
    v_cvt_pk_bf16_f32 v220, v50, v51
    v_cvt_pk_bf16_f32 v221, v52, v53
    v_cvt_pk_bf16_f32 v222, v54, v55
    v_cvt_pk_bf16_f32 v223, v56, v57
    ds_write_b128 v29, v[220:223] offset:128
    v_cvt_pk_bf16_f32 v216, v66, v67
    v_cvt_pk_bf16_f32 v217, v68, v69
    v_cvt_pk_bf16_f32 v218, v70, v71
    v_cvt_pk_bf16_f32 v219, v72, v73
    ds_write_b128 v29, v[216:219] offset:8192
    v_cvt_pk_bf16_f32 v220, v82, v83
    v_cvt_pk_bf16_f32 v221, v84, v85
    v_cvt_pk_bf16_f32 v222, v86, v87
    v_cvt_pk_bf16_f32 v223, v88, v89
    ds_write_b128 v29, v[220:223] offset:8320
    v_cvt_pk_bf16_f32 v216, v98, v99
    v_cvt_pk_bf16_f32 v217, v100, v101
    v_cvt_pk_bf16_f32 v218, v102, v103
    v_cvt_pk_bf16_f32 v219, v104, v105
    ds_write_b128 v29, v[216:219] offset:16384
    v_cvt_pk_bf16_f32 v220, v114, v115
    v_cvt_pk_bf16_f32 v221, v116, v117
    v_cvt_pk_bf16_f32 v222, v118, v119
    v_cvt_pk_bf16_f32 v223, v120, v121
    ds_write_b128 v29, v[220:223] offset:16512
    v_cvt_pk_bf16_f32 v216, v146, v147
    v_cvt_pk_bf16_f32 v217, v148, v149
    v_cvt_pk_bf16_f32 v218, v150, v151
    v_cvt_pk_bf16_f32 v219, v152, v153
    ds_write_b128 v29, v[216:219] offset:24576
    v_cvt_pk_bf16_f32 v220, v130, v131
    v_cvt_pk_bf16_f32 v221, v132, v133
    v_cvt_pk_bf16_f32 v222, v134, v135
    v_cvt_pk_bf16_f32 v223, v136, v137
    ds_write_b128 v29, v[220:223] offset:24704
    s_cmp_eq_u32 s55, 0
    s_cbranch_scc1 K1_NOSPEC0
    s_mov_b64 exec, 65535
    ds_write_b16 v183, v162 offset:24320
    ds_write_b16_d16_hi v183, v162 offset:24448
    ds_write_b16 v183, v163 offset:32512
    ds_write_b16_d16_hi v183, v163 offset:32640
    s_mov_b64 exec, -1
K1_NOSPEC0:
    s_waitcnt lgkmcnt(0)
    s_barrier
    v_pk_mul_f32 v[200:201], v[42:43], v[192:193]
    v_pk_mul_f32 v[202:203], v[58:59], v[192:193]
    v_pk_mul_f32 v[204:205], v[74:75], v[192:193]
    v_pk_mul_f32 v[206:207], v[90:91], v[192:193]
    v_pk_fma_f32 v[42:43], v[106:107], v[192:193], v[200:201]
    v_pk_fma_f32 v[106:107], v[106:107], v[192:193], v[200:201] neg_lo:[1,0,0] neg_hi:[1,0,0]
    v_pk_fma_f32 v[58:59], v[122:123], v[192:193], v[202:203]
    v_pk_fma_f32 v[122:123], v[122:123], v[192:193], v[202:203] neg_lo:[1,0,0] neg_hi:[1,0,0]
    v_pk_fma_f32 v[74:75], v[138:139], v[192:193], v[204:205]
    v_pk_fma_f32 v[138:139], v[138:139], v[192:193], v[204:205] neg_lo:[1,0,0] neg_hi:[1,0,0]
    v_pk_fma_f32 v[90:91], v[154:155], v[192:193], v[206:207]
    v_pk_fma_f32 v[154:155], v[154:155], v[192:193], v[206:207] neg_lo:[1,0,0] neg_hi:[1,0,0]
    v_pk_add_f32 v[42:43], v[42:43], v[74:75]
    v_pk_add_f32 v[58:59], v[58:59], v[90:91]
    v_pk_add_f32 v[106:107], v[106:107], v[154:155]
    v_pk_add_f32 v[122:123], v[122:123], v[138:139] neg_lo:[0,1] neg_hi:[0,1]
    v_pk_fma_f32 v[74:75], v[74:75], s[60:61], v[42:43] neg_lo:[1,0,0] neg_hi:[1,0,0]
    v_pk_fma_f32 v[90:91], v[90:91], s[60:61], v[58:59] neg_lo:[0,0,1] neg_hi:[0,0,1]
    v_pk_fma_f32 v[154:155], v[154:155], s[60:61], v[106:107] neg_lo:[1,0,0] neg_hi:[1,0,0]
    v_pk_fma_f32 v[138:139], v[138:139], s[60:61], v[122:123] neg_lo:[1,0,1] neg_hi:[1,0,1]
    v_pk_mul_f32 v[200:201], v[44:45], v[194:195]
    v_pk_mul_f32 v[202:203], v[60:61], v[194:195]
    v_pk_mul_f32 v[204:205], v[76:77], v[194:195]
    v_pk_mul_f32 v[206:207], v[92:93], v[194:195]
    v_pk_fma_f32 v[44:45], v[108:109], v[194:195], v[200:201]
    v_pk_fma_f32 v[108:109], v[108:109], v[194:195], v[200:201] neg_lo:[1,0,0] neg_hi:[1,0,0]
    v_pk_fma_f32 v[60:61], v[124:125], v[194:195], v[202:203]
    v_pk_fma_f32 v[124:125], v[124:125], v[194:195], v[202:203] neg_lo:[1,0,0] neg_hi:[1,0,0]
    v_pk_fma_f32 v[76:77], v[140:141], v[194:195], v[204:205]
    v_pk_fma_f32 v[140:141], v[140:141], v[194:195], v[204:205] neg_lo:[1,0,0] neg_hi:[1,0,0]
    v_pk_fma_f32 v[92:93], v[156:157], v[194:195], v[206:207]
    v_pk_fma_f32 v[156:157], v[156:157], v[194:195], v[206:207] neg_lo:[1,0,0] neg_hi:[1,0,0]
    v_pk_add_f32 v[44:45], v[44:45], v[76:77]
    v_pk_add_f32 v[60:61], v[60:61], v[92:93]
    v_pk_add_f32 v[108:109], v[108:109], v[156:157]
    v_pk_add_f32 v[124:125], v[124:125], v[140:141] neg_lo:[0,1] neg_hi:[0,1]
    v_pk_fma_f32 v[76:77], v[76:77], s[60:61], v[44:45] neg_lo:[1,0,0] neg_hi:[1,0,0]
    v_pk_fma_f32 v[92:93], v[92:93], s[60:61], v[60:61] neg_lo:[0,0,1] neg_hi:[0,0,1]
    v_pk_fma_f32 v[156:157], v[156:157], s[60:61], v[108:109] neg_lo:[1,0,0] neg_hi:[1,0,0]
    v_pk_fma_f32 v[140:141], v[140:141], s[60:61], v[124:125] neg_lo:[1,0,1] neg_hi:[1,0,1]
    v_pk_mul_f32 v[200:201], v[46:47], v[196:197]
    v_pk_mul_f32 v[202:203], v[62:63], v[196:197]
    v_pk_mul_f32 v[204:205], v[78:79], v[196:197]
    v_pk_mul_f32 v[206:207], v[94:95], v[196:197]
    v_pk_fma_f32 v[46:47], v[110:111], v[196:197], v[200:201]
    v_pk_fma_f32 v[110:111], v[110:111], v[196:197], v[200:201] neg_lo:[1,0,0] neg_hi:[1,0,0]
    v_pk_fma_f32 v[62:63], v[126:127], v[196:197], v[202:203]
    v_pk_fma_f32 v[126:127], v[126:127], v[196:197], v[202:203] neg_lo:[1,0,0] neg_hi:[1,0,0]
    v_pk_fma_f32 v[78:79], v[142:143], v[196:197], v[204:205]
    v_pk_fma_f32 v[142:143], v[142:143], v[196:197], v[204:205] neg_lo:[1,0,0] neg_hi:[1,0,0]
    v_pk_fma_f32 v[94:95], v[158:159], v[196:197], v[206:207]
    v_pk_fma_f32 v[158:159], v[158:159], v[196:197], v[206:207] neg_lo:[1,0,0] neg_hi:[1,0,0]
    v_pk_add_f32 v[46:47], v[46:47], v[78:79]
    v_pk_add_f32 v[62:63], v[62:63], v[94:95]
    v_pk_add_f32 v[110:111], v[110:111], v[158:159]
    v_pk_add_f32 v[126:127], v[126:127], v[142:143] neg_lo:[0,1] neg_hi:[0,1]
    v_pk_fma_f32 v[78:79], v[78:79], s[60:61], v[46:47] neg_lo:[1,0,0] neg_hi:[1,0,0]
    v_pk_fma_f32 v[94:95], v[94:95], s[60:61], v[62:63] neg_lo:[0,0,1] neg_hi:[0,0,1]
    v_pk_fma_f32 v[158:159], v[158:159], s[60:61], v[110:111] neg_lo:[1,0,0] neg_hi:[1,0,0]
    v_pk_fma_f32 v[142:143], v[142:143], s[60:61], v[126:127] neg_lo:[1,0,1] neg_hi:[1,0,1]
    v_pk_mul_f32 v[200:201], v[48:49], v[198:199]
    v_pk_mul_f32 v[202:203], v[64:65], v[198:199]
    v_pk_mul_f32 v[204:205], v[80:81], v[198:199]
    v_pk_mul_f32 v[206:207], v[96:97], v[198:199]
    v_pk_fma_f32 v[48:49], v[112:113], v[198:199], v[200:201]
    v_pk_fma_f32 v[112:113], v[112:113], v[198:199], v[200:201] neg_lo:[1,0,0] neg_hi:[1,0,0]
    v_pk_fma_f32 v[64:65], v[128:129], v[198:199], v[202:203]
    v_pk_fma_f32 v[128:129], v[128:129], v[198:199], v[202:203] neg_lo:[1,0,0] neg_hi:[1,0,0]
    v_pk_fma_f32 v[80:81], v[144:145], v[198:199], v[204:205]
    v_pk_fma_f32 v[144:145], v[144:145], v[198:199], v[204:205] neg_lo:[1,0,0] neg_hi:[1,0,0]
    v_pk_fma_f32 v[96:97], v[160:161], v[198:199], v[206:207]
    v_pk_fma_f32 v[160:161], v[160:161], v[198:199], v[206:207] neg_lo:[1,0,0] neg_hi:[1,0,0]
    v_pk_add_f32 v[48:49], v[48:49], v[80:81]
    v_pk_add_f32 v[64:65], v[64:65], v[96:97]
    v_pk_add_f32 v[112:113], v[112:113], v[160:161]
    v_pk_add_f32 v[128:129], v[128:129], v[144:145] neg_lo:[0,1] neg_hi:[0,1]
    v_pk_fma_f32 v[80:81], v[80:81], s[60:61], v[48:49] neg_lo:[1,0,0] neg_hi:[1,0,0]
    v_pk_fma_f32 v[96:97], v[96:97], s[60:61], v[64:65] neg_lo:[0,0,1] neg_hi:[0,0,1]
    v_pk_fma_f32 v[160:161], v[160:161], s[60:61], v[112:113] neg_lo:[1,0,0] neg_hi:[1,0,0]
    v_pk_fma_f32 v[144:145], v[144:145], s[60:61], v[128:129] neg_lo:[1,0,1] neg_hi:[1,0,1]
    v_cvt_pk_bf16_f32 v216, v42, v43
    v_cvt_pk_bf16_f32 v217, v44, v45
    v_cvt_pk_bf16_f32 v218, v46, v47
    v_cvt_pk_bf16_f32 v219, v48, v49
    ds_write_b128 v29, v[216:219] offset:32768
    v_cvt_pk_bf16_f32 v220, v58, v59
    v_cvt_pk_bf16_f32 v221, v60, v61
    v_cvt_pk_bf16_f32 v222, v62, v63
    v_cvt_pk_bf16_f32 v223, v64, v65
    ds_write_b128 v29, v[220:223] offset:32896
    v_cvt_pk_bf16_f32 v216, v74, v75
    v_cvt_pk_bf16_f32 v217, v76, v77
    v_cvt_pk_bf16_f32 v218, v78, v79
    v_cvt_pk_bf16_f32 v219, v80, v81
    ds_write_b128 v29, v[216:219] offset:40960
    v_cvt_pk_bf16_f32 v220, v90, v91
    v_cvt_pk_bf16_f32 v221, v92, v93
    v_cvt_pk_bf16_f32 v222, v94, v95
    v_cvt_pk_bf16_f32 v223, v96, v97
    ds_write_b128 v29, v[220:223] offset:41088
    v_cvt_pk_bf16_f32 v216, v106, v107
    v_cvt_pk_bf16_f32 v217, v108, v109
    v_cvt_pk_bf16_f32 v218, v110, v111
    v_cvt_pk_bf16_f32 v219, v112, v113
    ds_write_b128 v29, v[216:219] offset:49152
    v_cvt_pk_bf16_f32 v220, v122, v123
    v_cvt_pk_bf16_f32 v221, v124, v125
    v_cvt_pk_bf16_f32 v222, v126, v127
    v_cvt_pk_bf16_f32 v223, v128, v129
    ds_write_b128 v29, v[220:223] offset:49280
    v_cvt_pk_bf16_f32 v216, v154, v155
    v_cvt_pk_bf16_f32 v217, v156, v157
    v_cvt_pk_bf16_f32 v218, v158, v159
    v_cvt_pk_bf16_f32 v219, v160, v161
    ds_write_b128 v29, v[216:219] offset:57344
    v_cvt_pk_bf16_f32 v220, v138, v139
    v_cvt_pk_bf16_f32 v221, v140, v141
    v_cvt_pk_bf16_f32 v222, v142, v143
    v_cvt_pk_bf16_f32 v223, v144, v145
    ds_write_b128 v29, v[220:223] offset:57472
    s_cmp_eq_u32 s55, 0
    s_cbranch_scc1 K1_NOSPEC1
    s_mov_b64 exec, 4294901760
    ds_write_b16 v183, v162 offset:57088
    ds_write_b16_d16_hi v183, v162 offset:57216
    ds_write_b16 v183, v163 offset:65280
    ds_write_b16_d16_hi v183, v163 offset:65408
    s_mov_b64 exec, -1
K1_NOSPEC1:
    s_waitcnt lgkmcnt(0)
    s_barrier
    ds_read_b128 v[34:37], v30 offset:0
    ds_read_b128 v[38:41], v31 offset:1024
    ds_read_b128 v[42:45], v30 offset:2048
    ds_read_b128 v[46:49], v31 offset:3072
    ds_read_b128 v[50:53], v30 offset:4096
    ds_read_b128 v[54:57], v31 offset:5120
    ds_read_b128 v[58:61], v30 offset:6144
    ds_read_b128 v[62:65], v31 offset:7168
    s_waitcnt lgkmcnt(7)
    buffer_store_dwordx4 v[34:37], v32, s[12:15], s41 offen sc1
    s_add_u32 s41, s41, s43
    s_waitcnt lgkmcnt(6)
    buffer_store_dwordx4 v[38:41], v32, s[12:15], s41 offen sc1
    s_add_u32 s41, s41, s43
    s_waitcnt lgkmcnt(5)
    buffer_store_dwordx4 v[42:45], v32, s[12:15], s41 offen sc1
    s_add_u32 s41, s41, s43
    s_waitcnt lgkmcnt(4)
    buffer_store_dwordx4 v[46:49], v32, s[12:15], s41 offen sc1
    s_add_u32 s41, s41, s43
    s_waitcnt lgkmcnt(3)
    buffer_store_dwordx4 v[50:53], v32, s[12:15], s41 offen sc1
    s_add_u32 s41, s41, s43
    s_waitcnt lgkmcnt(2)
    buffer_store_dwordx4 v[54:57], v32, s[12:15], s41 offen sc1
    s_add_u32 s41, s41, s43
    s_waitcnt lgkmcnt(1)
    buffer_store_dwordx4 v[58:61], v32, s[12:15], s41 offen sc1
    s_add_u32 s41, s41, s43
    s_waitcnt lgkmcnt(0)
    buffer_store_dwordx4 v[62:65], v33, s[12:15], s41 offen sc1
    s_barrier
    v_lshrrev_b32 v3, 4, v1
    v_and_b32 v2, 15, v1
    v_cvt_f32_u32 v98, v2
    v_cvt_f32_u32 v99, v3
    s_lshl_b32 s3, s37, 4
    v_add_u32 v2, s3, v2
    v_cvt_f32_u32 v100, v2
    v_mul_f32 v4, 0x3c800000, v100
    v_mul_f32 v118, 0x41000000, v99
    v_mul_f32 v7, v118, v4
    v_mov_b32 v101, v7
    v_cos_f32 v102, v101
    v_sin_f32_e64 v110, v101
    v_fma_f32 v101, 1.0, v4, v7
    v_cos_f32 v103, v101
    v_sin_f32 v111, v101
    v_fma_f32 v101, 2.0, v4, v7
    v_cos_f32 v104, v101
    v_sin_f32 v112, v101
    v_mov_b32 v6, 0x40400000
    v_fma_f32 v101, v6, v4, v7
    v_cos_f32 v105, v101
    v_sin_f32 v113, v101
    v_fma_f32 v101, 4.0, v4, v7
    v_cos_f32 v106, v101
    v_sin_f32 v114, v101
    v_mov_b32 v6, 0x40a00000
    v_fma_f32 v101, v6, v4, v7
    v_cos_f32 v107, v101
    v_sin_f32 v115, v101
    v_mov_b32 v6, 0x40c00000
    v_fma_f32 v101, v6, v4, v7
    v_cos_f32 v108, v101
    v_sin_f32 v116, v101
    v_mov_b32 v6, 0x40e00000
    v_fma_f32 v101, v6, v4, v7
    v_cos_f32 v109, v101
    v_sin_f32 v117, v101
    v_cvt_pk_bf16_f32 v192, v102, v103
    v_cvt_pk_bf16_f32 v200, v110, v111
    v_cvt_pk_bf16_f32 v193, v104, v105
    v_cvt_pk_bf16_f32 v201, v112, v113
    v_cvt_pk_bf16_f32 v194, v106, v107
    v_cvt_pk_bf16_f32 v202, v114, v115
    v_cvt_pk_bf16_f32 v195, v108, v109
    v_cvt_pk_bf16_f32 v203, v116, v117
    v_add_f32 v118, 0x42000000, v118
    v_mul_f32 v7, v118, v4
    v_mov_b32 v101, v7
    v_cos_f32 v102, v101
    v_sin_f32 v110, v101
    v_fma_f32 v101, 1.0, v4, v7
    v_cos_f32 v103, v101
    v_sin_f32 v111, v101
    v_fma_f32 v101, 2.0, v4, v7
    v_cos_f32 v104, v101
    v_sin_f32 v112, v101
    v_mov_b32 v6, 0x40400000
    v_fma_f32 v101, v6, v4, v7
    v_cos_f32 v105, v101
    v_sin_f32 v113, v101
    v_fma_f32 v101, 4.0, v4, v7
    v_cos_f32 v106, v101
    v_sin_f32 v114, v101
    v_mov_b32 v6, 0x40a00000
    v_fma_f32 v101, v6, v4, v7
    v_cos_f32 v107, v101
    v_sin_f32 v115, v101
    v_mov_b32 v6, 0x40c00000
    v_fma_f32 v101, v6, v4, v7
    v_cos_f32 v108, v101
    v_sin_f32 v116, v101
    v_mov_b32 v6, 0x40e00000
    v_fma_f32 v101, v6, v4, v7
    v_cos_f32 v109, v101
    v_sin_f32 v117, v101
    v_cvt_pk_bf16_f32 v196, v102, v103
    v_cvt_pk_bf16_f32 v204, v110, v111
    v_cvt_pk_bf16_f32 v197, v104, v105
    v_cvt_pk_bf16_f32 v205, v112, v113
    v_cvt_pk_bf16_f32 v198, v106, v107
    v_cvt_pk_bf16_f32 v206, v114, v115
    v_cvt_pk_bf16_f32 v199, v108, v109
    v_cvt_pk_bf16_f32 v207, v116, v117
    v_mul_f32_e64 v118, 4.0, v99
    v_mul_f32 v4, 0x3d000000, v98
    v_mul_f32 v7, v118, v4
    v_mov_b32 v101, v7
    v_cos_f32 v102, v101
    v_sin_f32 v110, v101
    v_fma_f32 v101, 1.0, v4, v7
    v_cos_f32 v103, v101
    v_sin_f32 v111, v101
    v_fma_f32 v101, 2.0, v4, v7
    v_cos_f32 v104, v101
    v_sin_f32 v112, v101
    v_mov_b32 v6, 0x40400000
    v_fma_f32 v101, v6, v4, v7
    v_cos_f32 v105, v101
    v_sin_f32 v113, v101
    v_mov_b32 v6, 0x41800000
    v_fma_f32 v101, v6, v4, v7
    v_cos_f32 v106, v101
    v_sin_f32 v114, v101
    v_mov_b32 v6, 0x41880000
    v_fma_f32 v101, v6, v4, v7
    v_cos_f32 v107, v101
    v_sin_f32 v115, v101
    v_mov_b32 v6, 0x41900000
    v_fma_f32 v101, v6, v4, v7
    v_cos_f32 v108, v101
    v_sin_f32 v116, v101
    v_mov_b32 v6, 0x41980000
    v_fma_f32 v101, v6, v4, v7
    v_cos_f32 v109, v101
    v_sin_f32 v117, v101
    v_cvt_pk_bf16_f32 v208, v102, v103
    v_cvt_pk_bf16_f32 v216, v110, v111
    v_cvt_pk_bf16_f32 v209, v104, v105
    v_cvt_pk_bf16_f32 v217, v112, v113
    v_cvt_pk_bf16_f32 v210, v106, v107
    v_cvt_pk_bf16_f32 v218, v114, v115
    v_cvt_pk_bf16_f32 v211, v108, v109
    v_cvt_pk_bf16_f32 v219, v116, v117
    v_mul_f32 v4, 0x3d000000, v98
    v_add_f32 v4, 0.5, v4
    v_mul_f32 v7, v118, v4
    v_mov_b32 v101, v7
    v_cos_f32 v102, v101
    v_sin_f32 v110, v101
    v_fma_f32 v101, 1.0, v4, v7
    v_cos_f32 v103, v101
    v_sin_f32 v111, v101
    v_fma_f32 v101, 2.0, v4, v7
    v_cos_f32 v104, v101
    v_sin_f32 v112, v101
    v_mov_b32 v6, 0x40400000
    v_fma_f32 v101, v6, v4, v7
    v_cos_f32 v105, v101
    v_sin_f32 v113, v101
    v_mov_b32 v6, 0x41800000
    v_fma_f32 v101, v6, v4, v7
    v_cos_f32 v106, v101
    v_sin_f32 v114, v101
    v_mov_b32 v6, 0x41880000
    v_fma_f32 v101, v6, v4, v7
    v_cos_f32 v107, v101
    v_sin_f32_e64 v115, v101
    v_mov_b32 v6, 0x41900000
    v_fma_f32 v101, v6, v4, v7
    v_cos_f32 v108, v101
    v_sin_f32 v116, v101
    v_mov_b32 v6, 0x41980000
    v_fma_f32 v101, v6, v4, v7
    v_cos_f32 v109, v101
    v_sin_f32 v117, v101
    v_cvt_pk_bf16_f32 v212, v102, v103
    v_cvt_pk_bf16_f32 v220, v110, v111
    v_cvt_pk_bf16_f32 v213, v104, v105
    v_cvt_pk_bf16_f32 v221, v112, v113
    v_cvt_pk_bf16_f32 v214, v106, v107
    v_cvt_pk_bf16_f32 v222, v114, v115
    v_cvt_pk_bf16_f32 v215, v108, v109
    v_cvt_pk_bf16_f32 v223, v116, v117
    v_mul_f32 v4, 0x3a000000, v100
    v_mul_f32 v7, v118, v4
    v_mov_b32 v6, 0x00000000
    v_fma_f32 v101, v6, v4, v7
    v_cos_f32 v224, v101
    v_sin_f32 v232, v101
    v_mov_b32 v6, 0x3f800000
    v_fma_f32 v101, v6, v4, v7
    v_cos_f32 v225, v101
    v_sin_f32 v233, v101
    v_mov_b32 v6, 0x40000000
    v_fma_f32 v101, v6, v4, v7
    v_cos_f32 v226, v101
    v_sin_f32 v234, v101
    v_mov_b32 v6, 0x40400000
    v_fma_f32 v101, v6, v4, v7
    v_cos_f32 v227, v101
    v_sin_f32 v235, v101
    v_mov_b32 v6, 0x41800000
    v_fma_f32 v101, v6, v4, v7
    v_cos_f32 v228, v101
    v_sin_f32 v236, v101
    v_mov_b32 v6, 0x41880000
    v_fma_f32 v101, v6, v4, v7
    v_cos_f32 v229, v101
    v_sin_f32 v237, v101
    v_mov_b32 v6, 0x41900000
    v_fma_f32 v101, v6, v4, v7
    v_cos_f32 v230, v101
    v_sin_f32 v238, v101
    v_mov_b32 v6, 0x41980000
    v_fma_f32 v101, v6, v4, v7
    v_cos_f32 v231, v101
    v_sin_f32 v239, v101
    v_cvt_f32_u32 v6, s3
    v_add_f32 v118, v118, v6
    v_mul_f32 v4, 0x3a000000, v98
    v_mul_f32 v101, v118, v4
    v_cos_f32 v240, v101
    v_sin_f32 v248, v101
    v_add_f32 v101, v101, v4
    v_cos_f32 v241, v101
    v_sin_f32 v249, v101
    v_add_f32 v101, v101, v4
    v_cos_f32 v242, v101
    v_sin_f32 v250, v101
    v_add_f32 v101, v101, v4
    v_cos_f32 v243, v101
    v_sin_f32 v251, v101
    v_mul_f32 v4, 0x3a000000, v98
    v_add_f32 v4, 0x3c000000, v4
    v_mul_f32 v101, v118, v4
    v_cos_f32 v244, v101
    v_sin_f32 v252, v101
    v_add_f32 v101, v101, v4
    v_cos_f32 v245, v101
    v_sin_f32 v253, v101
    v_add_f32 v101, v101, v4
    v_cos_f32 v246, v101
    v_sin_f32 v254, v101
    v_add_f32 v101, v101, v4
    v_cos_f32 v247, v101
    v_sin_f32 v255, v101
    s_mov_b32 s16, 0x3a000000
    s_mov_b32 s17, 0x3a000000
    v_pk_mul_f32 v[240:241], v[240:241], s[16:17]
    v_pk_mul_f32 v[248:249], v[248:249], s[16:17]
    v_pk_mul_f32 v[242:243], v[242:243], s[16:17]
    v_pk_mul_f32 v[250:251], v[250:251], s[16:17]
    v_pk_mul_f32 v[244:245], v[244:245], s[16:17]
    v_pk_mul_f32 v[252:253], v[252:253], s[16:17]
    v_pk_mul_f32 v[246:247], v[246:247], s[16:17]
    v_pk_mul_f32 v[254:255], v[254:255], s[16:17]
    s_waitcnt vmcnt(0)
    s_barrier
P2_COMPUTE:
    s_lshr_b32 s38, s37, 1
    s_and_b32 s39, s37, 1
    v_lshlrev_b32 v8, 4, v1
    s_lshl_b32 s3, s38, 12
    s_add_u32 s3, s3, 114688
    v_add_u32 v9, s3, v8
    v_bfe_u32 v2, v1, 2, 2
    v_lshl_add_u32 v3, v5, 3, v2
    v_lshlrev_b32 v3, 8, v3
    s_lshl_b32 s3, s39, 1
    v_xor_b32 v2, s3, v2
    v_lshl_add_u32 v3, v2, 6, v3
    v_bfe_u32 v2, v1, 4, 1
    v_lshl_add_u32 v3, v2, 5, v3
    v_and_b32 v2, 1, v1
    v_lshl_add_u32 v3, v2, 4, v3
    v_bfe_u32 v2, v1, 1, 1
    v_lshl_add_u32 v16, v2, 3, v3
    v_xor_b32 v17, 64, v16
    v_add_u32 v18, 65536, v16
    v_add_u32 v19, 65536, v17
    s_barrier
    ds_read_b128 v[88:91], v9 offset:0
    ds_read_b64_tr_b16 v[100:101], v16 offset:49152
    ds_read_b64_tr_b16 v[102:103], v16 offset:50176
    ds_read_b64_tr_b16 v[104:105], v17 offset:49152
    ds_read_b64_tr_b16 v[106:107], v17 offset:50176
    ds_read_b128 v[92:95], v9 offset:1024
    ds_read_b64_tr_b16 v[108:109], v16 offset:53248
    ds_read_b64_tr_b16 v[110:111], v16 offset:54272
    ds_read_b64_tr_b16 v[112:113], v17 offset:53248
    ds_read_b64_tr_b16 v[114:115], v17 offset:54272
    s_waitcnt lgkmcnt(7)
    v_mfma_f32_32x32x16_bf16 v[24:39], v[100:103], v[88:91], 0
    ds_read_b128 v[96:99], v9 offset:2048
    ds_read_b64_tr_b16 v[116:117], v16 offset:57344
    ds_read_b64_tr_b16 v[118:119], v16 offset:58368
    s_bfe_u32 s32, s2, 0x20001
    s_and_b32 s3, s2, 1
    s_waitcnt lgkmcnt(8)
    v_mfma_f32_32x32x16_bf16 v[40:55], v[104:107], v[88:91], 0
    ds_read_b64_tr_b16 v[120:121], v17 offset:57344
    ds_read_b64_tr_b16 v[122:123], v17 offset:58368
    s_lshl_b32 s3, s3, 3
    s_lshr_b32 s33, s2, 5
    s_add_u32 s33, s33, s3
    s_waitcnt lgkmcnt(7)
    v_mfma_f32_32x32x16_bf16 v[24:39], v[108:111], v[92:95], v[24:39]
    ds_read_b128 v[88:91], v9 offset:3072
    ds_read_b64_tr_b16 v[100:101], v16 offset:61440
    ds_read_b64_tr_b16 v[102:103], v16 offset:62464
    s_bfe_u32 s64, s2, 0x20003
    s_lshl_b32 s65, s33, 2
    s_waitcnt lgkmcnt(8)
    v_mfma_f32_32x32x16_bf16 v[40:55], v[112:115], v[92:95], v[40:55]
    ds_read_b64_tr_b16 v[104:105], v17 offset:61440
    ds_read_b64_tr_b16 v[106:107], v17 offset:62464
    s_add_u32 s65, s65, s32
    v_lshrrev_b32 v3, 4, v1
    v_and_b32 v2, 15, v1
    s_waitcnt lgkmcnt(7)
    v_mfma_f32_32x32x16_bf16 v[24:39], v[116:119], v[96:99], v[24:39]
    s_waitcnt lgkmcnt(0)
    s_barrier
    ds_read_b128 v[92:95], v9 offset:8192
    ds_read_b64_tr_b16 v[108:109], v18 offset:0
    v_mfma_f32_32x32x16_bf16 v[40:55], v[120:123], v[96:99], v[40:55]
    ds_read_b64_tr_b16 v[110:111], v18 offset:1024
    ds_read_b64_tr_b16 v[112:113], v19 offset:0
    ds_read_b64_tr_b16 v[114:115], v19 offset:1024
    v_mfma_f32_32x32x16_bf16 v[24:39], v[100:103], v[88:91], v[24:39]
    ds_read_b128 v[96:99], v9 offset:9216
    ds_read_b64_tr_b16 v[116:117], v18 offset:4096
    ds_read_b64_tr_b16 v[118:119], v18 offset:5120
    v_lshrrev_b32 v4, 1, v3
    v_and_b32 v14, 1, v3
    v_mfma_f32_32x32x16_bf16 v[40:55], v[104:107], v[88:91], v[40:55]
    ds_read_b64_tr_b16 v[120:121], v19 offset:4096
    ds_read_b64_tr_b16 v[122:123], v19 offset:5120
    v_lshlrev_b32 v6, 5, v2
    v_lshl_add_u32 v6, v4, 9, v6
    v_lshl_add_u32 v6, v14, 4, v6
    s_waitcnt lgkmcnt(7)
    v_mfma_f32_32x32x16_bf16 v[24:39], v[108:111], v[92:95], v[24:39]
    ds_read_b128 v[88:91], v9 offset:10240
    ds_read_b64_tr_b16 v[100:101], v18 offset:8192
    ds_read_b64_tr_b16 v[102:103], v18 offset:9216
    v_add_u32 v10, 139264, v6
    v_lshrrev_b32 v6, 1, v2
    s_waitcnt lgkmcnt(8)
    v_mfma_f32_32x32x16_bf16 v[40:55], v[112:115], v[92:95], v[40:55]
    ds_read_b64_tr_b16 v[104:105], v19 offset:8192
    ds_read_b64_tr_b16 v[106:107], v19 offset:9216
    v_lshlrev_b32 v2, 7, v2
    v_add_u32 v2, 155648, v2
    v_xor_b32_e64 v7, v6, v3
    s_waitcnt lgkmcnt(7)
    v_mfma_f32_32x32x16_bf16 v[24:39], v[116:119], v[96:99], v[24:39]
    ds_read_b128 v[92:95], v9 offset:11264
    ds_read_b64_tr_b16 v[108:109], v18 offset:12288
    ds_read_b64_tr_b16 v[110:111], v18 offset:13312
    v_lshl_add_u32 v12, v7, 4, v2
    v_xor_b32 v13, 64, v12
    s_waitcnt lgkmcnt(8)
    v_mfma_f32_32x32x16_bf16 v[40:55], v[120:123], v[96:99], v[40:55]
    ds_read_b64_tr_b16 v[112:113], v19 offset:12288
    ds_read_b64_tr_b16 v[114:115], v19 offset:13312
    s_lshl_b32 s3, s37, 1
    v_add_u32 v4, s3, v4
    v_xor_b32 v4, v4, v6
    s_waitcnt lgkmcnt(7)
    v_mfma_f32_32x32x16_bf16 v[24:39], v[100:103], v[88:91], v[24:39]
    s_waitcnt lgkmcnt(0)
    s_barrier
    ds_read_b128 v[96:99], v9 offset:16384
    ds_read_b64_tr_b16 v[116:117], v18 offset:16384
    v_mfma_f32_32x32x16_bf16 v[40:55], v[104:107], v[88:91], v[40:55]
    ds_read_b64_tr_b16 v[118:119], v18 offset:17408
    ds_read_b64_tr_b16 v[120:121], v19 offset:16384
    ds_read_b64_tr_b16 v[122:123], v19 offset:17408
    v_mfma_f32_32x32x16_bf16 v[24:39], v[108:111], v[92:95], v[24:39]
    ds_read_b128 v[88:91], v9 offset:17408
    ds_read_b64_tr_b16 v[100:101], v18 offset:20480
    ds_read_b64_tr_b16 v[102:103], v18 offset:21504
    v_lshl_add_u32 v4, v4, 4, v2
    v_lshl_add_u32 v11, v14, 3, v4
    v_mfma_f32_32x32x16_bf16 v[40:55], v[112:115], v[92:95], v[40:55]
    ds_read_b64_tr_b16 v[104:105], v19 offset:20480
    ds_read_b64_tr_b16 v[106:107], v19 offset:21504
    s_lshl_b32 s3, s37, 11
    s_add_u32 s3, s3, 147456
    v_add_u32_e64 v15, s3, v8
    s_waitcnt lgkmcnt(7)
    v_mfma_f32_32x32x16_bf16 v[24:39], v[116:119], v[96:99], v[24:39]
    ds_read_b128 v[92:95], v9 offset:18432
    ds_read_b64_tr_b16 v[108:109], v18 offset:24576
    ds_read_b64_tr_b16 v[110:111], v18 offset:25600
    v_and_b32 v2, 15, v1
    v_lshlrev_b32_e64 v2, 6, v2
    s_waitcnt lgkmcnt(8)
    v_mfma_f32_32x32x16_bf16 v[40:55], v[120:123], v[96:99], v[40:55]
    ds_read_b64_tr_b16 v[112:113], v19 offset:24576
    ds_read_b64_tr_b16 v[114:115], v19 offset:25600
    v_lshl_add_u32 v2, v5, 4, v2
    v_bfe_u32 v3, v1, 4, 1
    v_lshl_add_u32 v14, v3, 5, v2
    s_waitcnt lgkmcnt(7)
    v_mfma_f32_32x32x16_bf16 v[24:39], v[100:103], v[88:91], v[24:39]
    ds_read_b128 v[96:99], v9 offset:19456
    ds_read_b64_tr_b16 v[116:117], v18 offset:28672
    ds_read_b64_tr_b16 v[118:119], v18 offset:29696
    s_lshl_b32 s3, s33, 2
    s_add_u32 s3, s3, s38
    s_waitcnt lgkmcnt(8)
    v_mfma_f32_32x32x16_bf16 v[40:55], v[104:107], v[88:91], v[40:55]
    ds_read_b64_tr_b16 v[120:121], v19 offset:28672
    ds_read_b64_tr_b16 v[122:123], v19 offset:29696
    s_lshl_b32 s3, s3, 1
    s_add_u32 s3, s3, s39
    s_lshl_b32 s3, s3, 2
    s_waitcnt lgkmcnt(7)
    v_mfma_f32_32x32x16_bf16 v[24:39], v[108:111], v[92:95], v[24:39]
    s_waitcnt lgkmcnt(0)
    s_barrier
    ds_read_b128 v[88:91], v9 offset:40960
    ds_read_b64_tr_b16 v[100:101], v18 offset:32768
    v_mfma_f32_32x32x16_bf16 v[40:55], v[112:115], v[92:95], v[40:55]
    ds_read_b64_tr_b16 v[102:103], v18 offset:33792
    ds_read_b64_tr_b16 v[104:105], v19 offset:32768
    ds_read_b64_tr_b16 v[106:107], v19 offset:33792
    v_mfma_f32_32x32x16_bf16 v[24:39], v[116:119], v[96:99], v[24:39]
    ds_read_b128 v[92:95], v9 offset:41984
    ds_read_b64_tr_b16 v[108:109], v18 offset:36864
    ds_read_b64_tr_b16 v[110:111], v18 offset:37888
    s_add_u32 s3, s3, s64
    s_lshl_b32 s3, s3, 12
    v_mfma_f32_32x32x16_bf16 v[40:55], v[120:123], v[96:99], v[40:55]
    ds_read_b64_tr_b16 v[112:113], v19 offset:36864
    ds_read_b64_tr_b16 v[114:115], v19 offset:37888
    s_lshl_b32 s43, s32, 21
    s_add_u32 s3, s3, s43
    s_add_u32 s54, s3, 13631488
    s_waitcnt lgkmcnt(7)
    v_mfma_f32_32x32x16_bf16 v[24:39], v[100:103], v[88:91], v[24:39]
    ds_read_b128 v[96:99], v9 offset:43008
    ds_read_b64_tr_b16 v[116:117], v18 offset:40960
    ds_read_b64_tr_b16 v[118:119], v18 offset:41984
    s_add_u32 s55, s54, 65536
    s_sub_u32 s50, s32, s38
    s_waitcnt lgkmcnt(8)
    v_mfma_f32_32x32x16_bf16 v[40:55], v[104:107], v[88:91], v[40:55]
    ds_read_b64_tr_b16 v[120:121], v19 offset:40960
    ds_read_b64_tr_b16 v[122:123], v19 offset:41984
    v_and_b32 v2, 31, v1
    s_lshl_b32 s3, s39, 13
    s_add_u32 s3, s3, 98304
    s_waitcnt lgkmcnt(7)
    v_mfma_f32_32x32x16_bf16 v[24:39], v[108:111], v[92:95], v[24:39]
    ds_read_b128 v[88:91], v9 offset:44032
    ds_read_b64_tr_b16 v[100:101], v18 offset:45056
    ds_read_b64_tr_b16 v[102:103], v18 offset:46080
    v_lshl_add_u32 v2, v2, 8, s3
    v_and_b32 v4, 7, v1
    s_waitcnt lgkmcnt(8)
    v_mfma_f32_32x32x16_bf16 v[40:55], v[112:115], v[92:95], v[40:55]
    ds_read_b64_tr_b16 v[104:105], v19 offset:45056
    ds_read_b64_tr_b16 v[106:107], v19 offset:46080
    v_lshlrev_b32 v6, 1, v5
    v_xor_b32 v4, v4, v6
    v_xor_b32 v6, 0, v4
    s_waitcnt lgkmcnt(7)
    v_mfma_f32_32x32x16_bf16 v[24:39], v[116:119], v[96:99], v[24:39]
    s_waitcnt vmcnt(0) lgkmcnt(0)
    s_barrier
    ds_read_b128 v[92:95], v9 offset:0
    ds_read_b64_tr_b16 v[108:109], v16 offset:0
    v_mfma_f32_32x32x16_bf16 v[40:55], v[120:123], v[96:99], v[40:55]
    ds_read_b64_tr_b16 v[110:111], v16 offset:1024
    ds_read_b64_tr_b16 v[112:113], v17 offset:0
    ds_read_b64_tr_b16 v[114:115], v17 offset:1024
    v_mfma_f32_32x32x16_bf16 v[24:39], v[100:103], v[88:91], v[24:39]
    ds_read_b128 v[96:99], v9 offset:1024
    ds_read_b64_tr_b16 v[116:117], v16 offset:4096
    ds_read_b64_tr_b16 v[118:119], v16 offset:5120
    v_lshl_add_u32 v20, v6, 4, v2
    v_xor_b32_e64 v6, 1, v4
    v_mfma_f32_32x32x16_bf16 v[40:55], v[104:107], v[88:91], v[40:55]
    ds_read_b64_tr_b16 v[120:121], v17 offset:4096
    ds_read_b64_tr_b16 v[122:123], v17 offset:5120
    v_lshl_add_u32 v21, v6, 4, v2
    v_xor_b32 v6, 4, v4
    v_lshl_add_u32 v22, v6, 4, v2
    s_waitcnt lgkmcnt(7)
    v_mfma_f32_32x32x16_bf16 v[24:39], v[108:111], v[92:95], v[24:39]
    ds_read_b128 v[88:91], v9 offset:2048
    ds_read_b64_tr_b16 v[100:101], v16 offset:8192
    ds_read_b64_tr_b16 v[102:103], v16 offset:9216
    v_xor_b32_e64 v6, 5, v4
    v_lshl_add_u32 v23, v6, 4, v2
    s_waitcnt lgkmcnt(8)
    v_mfma_f32_32x32x16_bf16 v[40:55], v[112:115], v[92:95], v[40:55]
    ds_read_b64_tr_b16 v[104:105], v17 offset:8192
    ds_read_b64_tr_b16 v[106:107], v17 offset:9216
    s_lshl_b32 s3, s2, 13
    s_lshl_b32 s43, s37, 10
    s_add_u32 s3, s3, s43
    s_waitcnt lgkmcnt(7)
    v_mfma_f32_32x32x16_bf16 v[24:39], v[116:119], v[96:99], v[24:39]
    ds_read_b128 v[92:95], v9 offset:3072
    ds_read_b64_tr_b16 v[108:109], v16 offset:12288
    ds_read_b64_tr_b16 v[110:111], v16 offset:13312
    s_add_u32 s44, s3, 11534336
    s_add_u32 s45, s44, 4096
    s_waitcnt lgkmcnt(8)
    v_mfma_f32_32x32x16_bf16 v[40:55], v[120:123], v[96:99], v[40:55]
    ds_read_b64_tr_b16 v[112:113], v17 offset:12288
    ds_read_b64_tr_b16 v[114:115], v17 offset:13312
    s_mov_b32 s47, 0x80008000
    v_xor_b32 v156, s47, v200
    v_xor_b32 v164, s47, v216
    s_waitcnt lgkmcnt(7)
    v_mfma_f32_32x32x16_bf16 v[24:39], v[100:103], v[88:91], v[24:39]
    ds_read_b128 v[96:99], v9 offset:8192
    ds_read_b64_tr_b16 v[116:117], v16 offset:16384
    ds_read_b64_tr_b16 v[118:119], v16 offset:17408
    v_xor_b32 v157, s47, v201
    v_xor_b32 v165, s47, v217
    s_waitcnt lgkmcnt(8)
    v_mfma_f32_32x32x16_bf16 v[40:55], v[104:107], v[88:91], v[40:55]
    ds_read_b64_tr_b16 v[120:121], v17 offset:16384
    ds_read_b64_tr_b16 v[122:123], v17 offset:17408
    v_xor_b32 v158, s47, v202
    v_xor_b32 v166, s47, v218
    v_xor_b32 v159, s47, v203
    s_waitcnt lgkmcnt(7)
    v_mfma_f32_32x32x16_bf16 v[24:39], v[108:111], v[92:95], v[24:39]
    ds_read_b128 v[88:91], v9 offset:9216
    ds_read_b64_tr_b16 v[100:101], v16 offset:20480
    ds_read_b64_tr_b16 v[102:103], v16 offset:21504
    v_xor_b32 v167, s47, v219
    v_xor_b32 v160, s47, v204
    s_waitcnt lgkmcnt(8)
    v_mfma_f32_32x32x16_bf16 v[40:55], v[112:115], v[92:95], v[40:55]
    ds_read_b64_tr_b16 v[104:105], v17 offset:20480
    ds_read_b64_tr_b16 v[106:107], v17 offset:21504
    v_xor_b32 v168, s47, v220
    v_xor_b32 v161, s47, v205
    v_xor_b32_e64 v169, s47, v221
    s_waitcnt lgkmcnt(7)
    v_mfma_f32_32x32x16_bf16 v[24:39], v[116:119], v[96:99], v[24:39]
    ds_read_b128 v[92:95], v9 offset:10240
    ds_read_b64_tr_b16 v[108:109], v16 offset:24576
    ds_read_b64_tr_b16 v[110:111], v16 offset:25600
    v_xor_b32 v162, s47, v206
    v_xor_b32_e64 v170, s47, v222
    s_waitcnt lgkmcnt(8)
    v_mfma_f32_32x32x16_bf16 v[40:55], v[120:123], v[96:99], v[40:55]
    ds_read_b64_tr_b16 v[112:113], v17 offset:24576
    ds_read_b64_tr_b16 v[114:115], v17 offset:25600
    v_xor_b32 v163, s47, v207
    v_xor_b32 v171, s47, v223
    s_waitcnt lgkmcnt(7)
    v_mfma_f32_32x32x16_bf16 v[24:39], v[100:103], v[88:91], v[24:39]
    ds_read_b128 v[96:99], v9 offset:11264
    ds_read_b64_tr_b16 v[116:117], v16 offset:28672
    ds_read_b64_tr_b16 v[118:119], v16 offset:29696
    s_waitcnt lgkmcnt(8)
    v_mfma_f32_32x32x16_bf16 v[40:55], v[104:107], v[88:91], v[40:55]
    ds_read_b64_tr_b16 v[120:121], v17 offset:28672
    ds_read_b64_tr_b16 v[122:123], v17 offset:29696
    s_waitcnt lgkmcnt(7)
    v_mfma_f32_32x32x16_bf16 v[24:39], v[108:111], v[92:95], v[24:39]
    ds_read_b128 v[88:91], v9 offset:16384
    ds_read_b64_tr_b16 v[100:101], v16 offset:32768
    ds_read_b64_tr_b16 v[102:103], v16 offset:33792
    s_waitcnt lgkmcnt(8)
    v_mfma_f32_32x32x16_bf16 v[40:55], v[112:115], v[92:95], v[40:55]
    ds_read_b64_tr_b16 v[104:105], v17 offset:32768
    ds_read_b64_tr_b16 v[106:107], v17 offset:33792
    s_waitcnt lgkmcnt(7)
    v_mfma_f32_32x32x16_bf16 v[24:39], v[116:119], v[96:99], v[24:39]
    ds_read_b128 v[92:95], v9 offset:17408
    ds_read_b64_tr_b16 v[108:109], v16 offset:36864
    ds_read_b64_tr_b16 v[110:111], v16 offset:37888
    s_waitcnt lgkmcnt(8)
    v_mfma_f32_32x32x16_bf16 v[40:55], v[120:123], v[96:99], v[40:55]
    ds_read_b64_tr_b16 v[112:113], v17 offset:36864
    ds_read_b64_tr_b16 v[114:115], v17 offset:37888
    s_waitcnt lgkmcnt(7)
    v_mfma_f32_32x32x16_bf16 v[24:39], v[100:103], v[88:91], v[24:39]
    ds_read_b128 v[96:99], v9 offset:18432
    ds_read_b64_tr_b16 v[116:117], v16 offset:40960
    ds_read_b64_tr_b16 v[118:119], v16 offset:41984
    s_waitcnt lgkmcnt(8)
    v_mfma_f32_32x32x16_bf16 v[40:55], v[104:107], v[88:91], v[40:55]
    ds_read_b64_tr_b16 v[120:121], v17 offset:40960
    ds_read_b64_tr_b16 v[122:123], v17 offset:41984
    s_waitcnt lgkmcnt(7)
    v_mfma_f32_32x32x16_bf16 v[24:39], v[108:111], v[92:95], v[24:39]
    ds_read_b128 v[88:91], v9 offset:19456
    ds_read_b64_tr_b16 v[100:101], v16 offset:45056
    ds_read_b64_tr_b16 v[102:103], v16 offset:46080
    s_waitcnt lgkmcnt(8)
    v_mfma_f32_32x32x16_bf16 v[40:55], v[112:115], v[92:95], v[40:55]
    ds_read_b64_tr_b16 v[104:105], v17 offset:45056
    ds_read_b64_tr_b16 v[106:107], v17 offset:46080
    s_waitcnt lgkmcnt(7)
    v_mfma_f32_32x32x16_bf16 v[24:39], v[116:119], v[96:99], v[24:39]
    s_waitcnt lgkmcnt(5)
    v_mfma_f32_32x32x16_bf16 v[40:55], v[120:123], v[96:99], v[40:55]
    s_waitcnt lgkmcnt(2)
    v_mfma_f32_32x32x16_bf16 v[24:39], v[100:103], v[88:91], v[24:39]
    s_waitcnt lgkmcnt(0)
    v_mfma_f32_32x32x16_bf16 v[40:55], v[104:107], v[88:91], v[40:55]
    s_nop 9
    s_cmp_eq_u32 s50, 0
    s_cbranch_scc1 P2_KEEPA
    v_cvt_pk_bf16_f32 v124, v24, v25
    v_cvt_pk_bf16_f32 v125, v26, v27
    v_cvt_pk_bf16_f32 v126, v28, v29
    v_cvt_pk_bf16_f32 v127, v30, v31
    v_cvt_pk_bf16_f32 v128, v32, v33
    v_cvt_pk_bf16_f32 v129, v34, v35
    v_cvt_pk_bf16_f32 v130, v36, v37
    v_cvt_pk_bf16_f32 v131, v38, v39
    v_permlane16_swap_b32 v124, v128
    v_permlane16_swap_b32 v125, v129
    v_permlane16_swap_b32 v126, v130
    v_permlane16_swap_b32 v127, v131
    buffer_store_dwordx4 v[124:127], v14, s[12:15], s54 offen offset:0 sc1
    buffer_store_dwordx4 v[128:131], v14, s[12:15], s54 offen offset:1024 sc1
    v_cvt_pk_bf16_f32 v132, v40, v41
    v_cvt_pk_bf16_f32 v133, v42, v43
    v_cvt_pk_bf16_f32 v134, v44, v45
    v_cvt_pk_bf16_f32 v135, v46, v47
    v_cvt_pk_bf16_f32 v136, v48, v49
    v_cvt_pk_bf16_f32 v137, v50, v51
    v_cvt_pk_bf16_f32 v138, v52, v53
    v_cvt_pk_bf16_f32 v139, v54, v55
    v_permlane16_swap_b32 v132, v136
    v_permlane16_swap_b32 v133, v137
    v_permlane16_swap_b32 v134, v138
    v_permlane16_swap_b32 v135, v139
    buffer_store_dwordx4 v[132:135], v14, s[12:15], s54 offen offset:2048 sc1
    buffer_store_dwordx4 v[136:139], v14, s[12:15], s54 offen offset:3072 sc1
P2_KEEPA:
    s_barrier
    ds_read_b128 v[88:91], v10 offset:0
    ds_read_b128 v[104:107], v10 offset:4096
    ds_read_b128 v[92:95], v10 offset:1024
    ds_read_b128 v[108:111], v10 offset:5120
    ds_read_b128 v[96:99], v10 offset:2048
    ds_read_b128 v[112:115], v10 offset:6144
    ds_read_b128 v[100:103], v10 offset:3072
    ds_read_b128 v[116:119], v10 offset:7168
    ds_read_b128 v[140:143], v15 offset:0
    ds_read_b128 v[144:147], v15 offset:1024
    s_mov_b32 s46, 0xffff0000
    s_waitcnt lgkmcnt(9)
    v_mfma_f32_16x16x32_bf16 v[56:59], v[88:91], v[192:195], 0
    v_mfma_f32_16x16x32_bf16 v[64:67], v[88:91], v[156:159], 0
    s_waitcnt lgkmcnt(8)
    v_mfma_f32_16x16x32_bf16 v[56:59], v[104:107], v[200:203], v[56:59]
    v_mfma_f32_16x16x32_bf16 v[64:67], v[104:107], v[192:195], v[64:67]
    s_waitcnt lgkmcnt(7)
    v_mfma_f32_16x16x32_bf16 v[56:59], v[92:95], v[196:199], v[56:59]
    v_mfma_f32_16x16x32_bf16 v[64:67], v[92:95], v[160:163], v[64:67]
    s_waitcnt lgkmcnt(6)
    v_mfma_f32_16x16x32_bf16 v[56:59], v[108:111], v[204:207], v[56:59]
    v_mfma_f32_16x16x32_bf16 v[64:67], v[108:111], v[196:199], v[64:67]
    s_waitcnt lgkmcnt(5)
    v_mfma_f32_16x16x32_bf16 v[60:63], v[96:99], v[192:195], 0
    s_waitcnt lgkmcnt(1)
    v_lshlrev_b32 v124, 16, v140
    v_and_b32 v132, s46, v140
    v_mfma_f32_16x16x32_bf16 v[68:71], v[96:99], v[156:159], 0
    v_lshlrev_b32 v125, 16, v141
    v_and_b32 v133, s46, v141
    v_mfma_f32_16x16x32_bf16 v[60:63], v[112:115], v[200:203], v[60:63]
    v_lshlrev_b32 v126, 16, v142
    v_and_b32 v134, s46, v142
    v_mfma_f32_16x16x32_bf16 v[68:71], v[112:115], v[192:195], v[68:71]
    v_lshlrev_b32 v127, 16, v143
    v_and_b32 v135, s46, v143
    v_mfma_f32_16x16x32_bf16 v[60:63], v[100:103], v[196:199], v[60:63]
    s_waitcnt lgkmcnt(0)
    v_lshlrev_b32 v128, 16, v144
    v_and_b32 v136, s46, v144
    v_mfma_f32_16x16x32_bf16 v[68:71], v[100:103], v[160:163], v[68:71]
    v_lshlrev_b32 v129, 16, v145
    v_and_b32 v137, s46, v145
    v_mfma_f32_16x16x32_bf16 v[60:63], v[116:119], v[204:207], v[60:63]
    v_lshlrev_b32 v130, 16, v146
    v_and_b32 v138, s46, v146
    v_mfma_f32_16x16x32_bf16 v[68:71], v[116:119], v[196:199], v[68:71]
    v_lshlrev_b32 v131, 16, v147
    v_and_b32_e64 v139, s46, v147
    v_pk_mul_f32 v[72:73], v[56:57], v[224:225]
    v_pk_mul_f32 v[80:81], v[64:65], v[224:225]
    v_pk_fma_f32 v[72:73], v[64:65], v[232:233], v[72:73]
    v_pk_fma_f32 v[80:81], v[56:57], v[232:233], v[80:81] neg_lo:[0,1,0] neg_hi:[0,1,0]
    v_pk_mul_f32 v[74:75], v[58:59], v[226:227]
    v_pk_mul_f32 v[82:83], v[66:67], v[226:227]
    v_pk_fma_f32 v[74:75], v[66:67], v[234:235], v[74:75]
    v_pk_fma_f32 v[82:83], v[58:59], v[234:235], v[82:83] neg_lo:[0,1,0] neg_hi:[0,1,0]
    v_pk_mul_f32 v[76:77], v[60:61], v[228:229]
    v_pk_mul_f32 v[84:85], v[68:69], v[228:229]
    v_pk_fma_f32 v[76:77], v[68:69], v[236:237], v[76:77]
    v_pk_fma_f32 v[84:85], v[60:61], v[236:237], v[84:85] neg_lo:[0,1,0] neg_hi:[0,1,0]
    v_pk_mul_f32 v[78:79], v[62:63], v[230:231]
    v_pk_mul_f32 v[86:87], v[70:71], v[230:231]
    v_pk_fma_f32 v[78:79], v[70:71], v[238:239], v[78:79]
    v_pk_fma_f32 v[86:87], v[62:63], v[238:239], v[86:87] neg_lo:[0,1,0] neg_hi:[0,1,0]
    v_cvt_pk_bf16_f32 v148, v72, v73
    v_cvt_pk_bf16_f32 v149, v74, v75
    v_cvt_pk_bf16_f32 v150, v76, v77
    v_cvt_pk_bf16_f32 v151, v78, v79
    v_cvt_pk_bf16_f32 v152, v80, v81
    v_cvt_pk_bf16_f32 v153, v82, v83
    v_cvt_pk_bf16_f32 v154, v84, v85
    v_cvt_pk_bf16_f32 v155, v86, v87
    v_mfma_f32_16x16x32_bf16 v[56:59], v[208:211], v[148:151], 0
    v_mfma_f32_16x16x32_bf16 v[64:67], v[164:167], v[148:151], 0
    v_mfma_f32_16x16x32_bf16 v[56:59], v[216:219], v[152:155], v[56:59]
    v_mfma_f32_16x16x32_bf16 v[64:67], v[208:211], v[152:155], v[64:67]
    v_mfma_f32_16x16x32_bf16 v[60:63], v[212:215], v[148:151], 0
    v_mfma_f32_16x16x32_bf16 v[68:71], v[168:171], v[148:151], 0
    v_mfma_f32_16x16x32_bf16 v[60:63], v[220:223], v[152:155], v[60:63]
    v_mfma_f32_16x16x32_bf16 v[68:71], v[212:215], v[152:155], v[68:71]
    s_nop 2
    v_pk_mul_f32 v[72:73], v[56:57], v[124:125]
    v_pk_mul_f32 v[80:81], v[64:65], v[124:125]
    v_pk_fma_f32 v[72:73], v[64:65], v[132:133], v[72:73] neg_lo:[0,1,0] neg_hi:[0,1,0]
    v_pk_fma_f32 v[80:81], v[56:57], v[132:133], v[80:81]
    v_pk_mul_f32 v[74:75], v[58:59], v[126:127]
    v_pk_mul_f32 v[82:83], v[66:67], v[126:127]
    v_pk_fma_f32 v[74:75], v[66:67], v[134:135], v[74:75] neg_lo:[0,1,0] neg_hi:[0,1,0]
    v_pk_fma_f32 v[82:83], v[58:59], v[134:135], v[82:83]
    v_pk_mul_f32 v[76:77], v[60:61], v[128:129]
    v_pk_mul_f32 v[84:85], v[68:69], v[128:129]
    v_pk_fma_f32 v[76:77], v[68:69], v[136:137], v[76:77] neg_lo:[0,1,0] neg_hi:[0,1,0]
    v_pk_fma_f32 v[84:85], v[60:61], v[136:137], v[84:85]
    v_pk_mul_f32 v[78:79], v[62:63], v[130:131]
    v_pk_mul_f32 v[86:87], v[70:71], v[130:131]
    v_pk_fma_f32 v[78:79], v[70:71], v[138:139], v[78:79] neg_lo:[0,1,0] neg_hi:[0,1,0]
    v_pk_fma_f32 v[86:87], v[62:63], v[138:139], v[86:87]
    v_cvt_pk_bf16_f32 v148, v72, v73
    v_cvt_pk_bf16_f32 v149, v74, v75
    v_cvt_pk_bf16_f32 v150, v76, v77
    v_cvt_pk_bf16_f32 v151, v78, v79
    v_cvt_pk_bf16_f32 v152, v80, v81
    v_cvt_pk_bf16_f32 v153, v82, v83
    v_cvt_pk_bf16_f32 v154, v84, v85
    v_cvt_pk_bf16_f32 v155, v86, v87
    v_mfma_f32_16x16x32_bf16 v[56:59], v[148:151], v[208:211], 0
    v_mfma_f32_16x16x32_bf16 v[64:67], v[148:151], v[216:219], 0
    v_mfma_f32_16x16x32_bf16 v[56:59], v[152:155], v[164:167], v[56:59]
    v_mfma_f32_16x16x32_bf16 v[64:67], v[152:155], v[208:211], v[64:67]
    v_mfma_f32_16x16x32_bf16 v[60:63], v[148:151], v[212:215], 0
    v_mfma_f32_16x16x32_bf16 v[68:71], v[148:151], v[220:223], 0
    v_mfma_f32_16x16x32_bf16 v[60:63], v[152:155], v[168:171], v[60:63]
    v_mfma_f32_16x16x32_bf16 v[68:71], v[152:155], v[212:215], v[68:71]
    s_nop 2
    v_pk_mul_f32 v[72:73], v[56:57], v[240:241]
    v_pk_mul_f32 v[80:81], v[64:65], v[240:241]
    v_pk_fma_f32 v[72:73], v[64:65], v[248:249], v[72:73] neg_lo:[0,1,0] neg_hi:[0,1,0]
    v_pk_fma_f32 v[80:81], v[56:57], v[248:249], v[80:81]
    v_pk_mul_f32 v[74:75], v[58:59], v[242:243]
    v_pk_mul_f32 v[82:83], v[66:67], v[242:243]
    v_pk_fma_f32 v[74:75], v[66:67], v[250:251], v[74:75] neg_lo:[0,1,0] neg_hi:[0,1,0]
    v_pk_fma_f32 v[82:83], v[58:59], v[250:251], v[82:83]
    v_pk_mul_f32 v[76:77], v[60:61], v[244:245]
    v_pk_mul_f32 v[84:85], v[68:69], v[244:245]
    v_pk_fma_f32 v[76:77], v[68:69], v[252:253], v[76:77] neg_lo:[0,1,0] neg_hi:[0,1,0]
    v_pk_fma_f32 v[84:85], v[60:61], v[252:253], v[84:85]
    v_pk_mul_f32 v[78:79], v[62:63], v[246:247]
    v_pk_mul_f32 v[86:87], v[70:71], v[246:247]
    v_pk_fma_f32 v[78:79], v[70:71], v[254:255], v[78:79] neg_lo:[0,1,0] neg_hi:[0,1,0]
    v_pk_fma_f32 v[86:87], v[62:63], v[254:255], v[86:87]
    v_cvt_pk_bf16_f32 v148, v72, v73
    v_cvt_pk_bf16_f32 v149, v74, v75
    v_cvt_pk_bf16_f32 v150, v76, v77
    v_cvt_pk_bf16_f32 v151, v78, v79
    v_cvt_pk_bf16_f32 v152, v80, v81
    v_cvt_pk_bf16_f32 v153, v82, v83
    v_cvt_pk_bf16_f32 v154, v84, v85
    v_cvt_pk_bf16_f32 v155, v86, v87
    ds_write_b64 v11, v[148:149] offset:0
    ds_write_b64 v11, v[150:151] offset:2048
    ds_write_b64 v11, v[152:153] offset:4096
    ds_write_b64 v11, v[154:155] offset:6144
    s_waitcnt lgkmcnt(0)
    s_barrier
    ds_read_b128 v[88:91], v12 offset:0
    ds_read_b128 v[104:107], v12 offset:4096
    ds_read_b128 v[92:95], v13 offset:0
    ds_read_b128 v[108:111], v13 offset:4096
    ds_read_b128 v[96:99], v12 offset:2048
    ds_read_b128 v[112:115], v12 offset:6144
    ds_read_b128 v[100:103], v13 offset:2048
    ds_read_b128 v[116:119], v13 offset:6144
    s_waitcnt lgkmcnt(7)
    v_mfma_f32_16x16x32_bf16 v[56:59], v[88:91], v[192:195], 0
    v_mfma_f32_16x16x32_bf16 v[64:67], v[88:91], v[200:203], 0
    s_waitcnt lgkmcnt(6)
    v_mfma_f32_16x16x32_bf16 v[56:59], v[104:107], v[156:159], v[56:59]
    v_mfma_f32_16x16x32_bf16 v[64:67], v[104:107], v[192:195], v[64:67]
    s_waitcnt lgkmcnt(5)
    v_mfma_f32_16x16x32_bf16 v[56:59], v[92:95], v[196:199], v[56:59]
    v_mfma_f32_16x16x32_bf16 v[64:67], v[92:95], v[204:207], v[64:67]
    s_waitcnt lgkmcnt(4)
    v_mfma_f32_16x16x32_bf16 v[56:59], v[108:111], v[160:163], v[56:59]
    v_mfma_f32_16x16x32_bf16 v[64:67], v[108:111], v[196:199], v[64:67]
    s_waitcnt lgkmcnt(3)
    v_mfma_f32_16x16x32_bf16 v[60:63], v[96:99], v[192:195], 0
    v_mfma_f32_16x16x32_bf16 v[68:71], v[96:99], v[200:203], 0
    s_waitcnt lgkmcnt(2)
    v_mfma_f32_16x16x32_bf16 v[60:63], v[112:115], v[156:159], v[60:63]
    v_mfma_f32_16x16x32_bf16 v[68:71], v[112:115], v[192:195], v[68:71]
    s_waitcnt lgkmcnt(1)
    v_mfma_f32_16x16x32_bf16 v[60:63], v[100:103], v[196:199], v[60:63]
    v_mfma_f32_16x16x32_bf16 v[68:71], v[100:103], v[204:207], v[68:71]
    s_waitcnt lgkmcnt(0)
    v_mfma_f32_16x16x32_bf16 v[60:63], v[116:119], v[160:163], v[60:63]
    v_mfma_f32_16x16x32_bf16 v[68:71], v[116:119], v[196:199], v[68:71]
    v_cvt_pk_bf16_f32 v148, v56, v57
    v_cvt_pk_bf16_f32 v149, v58, v59
    s_nop 4
    v_cvt_pk_bf16_f32 v150, v60, v61
    v_cvt_pk_bf16_f32 v151, v62, v63
    buffer_store_dwordx4 v[148:151], v8, s[12:15], s44 offen sc1
    v_cvt_pk_bf16_f32 v152, v64, v65
    v_cvt_pk_bf16_f32 v153, v66, v67
    v_cvt_pk_bf16_f32 v154, v68, v69
    v_cvt_pk_bf16_f32 v155, v70, v71
    buffer_store_dwordx4 v[152:155], v8, s[12:15], s45 offen sc1
    s_barrier
    ds_read_b128 v[92:95], v9 offset:0
    ds_read_b64_tr_b16 v[108:109], v16 offset:49152
    ds_read_b64_tr_b16 v[110:111], v16 offset:50176
    ds_read_b64_tr_b16 v[112:113], v17 offset:49152
    ds_read_b64_tr_b16 v[114:115], v17 offset:50176
    ds_read_b128 v[96:99], v9 offset:1024
    ds_read_b64_tr_b16 v[116:117], v16 offset:53248
    ds_read_b64_tr_b16 v[118:119], v16 offset:54272
    ds_read_b64_tr_b16 v[120:121], v17 offset:53248
    ds_read_b64_tr_b16 v[122:123], v17 offset:54272
    s_waitcnt lgkmcnt(7)
    v_mfma_f32_32x32x16_bf16 v[56:71], v[108:111], v[92:95], 0
    ds_read_b128 v[88:91], v9 offset:2048
    ds_read_b64_tr_b16 v[100:101], v16 offset:57344
    ds_read_b64_tr_b16 v[102:103], v16 offset:58368
    s_waitcnt lgkmcnt(8)
    v_mfma_f32_32x32x16_bf16 v[72:87], v[112:115], v[92:95], 0
    ds_read_b64_tr_b16 v[104:105], v17 offset:57344
    ds_read_b64_tr_b16 v[106:107], v17 offset:58368
    s_waitcnt lgkmcnt(7)
    v_mfma_f32_32x32x16_bf16 v[56:71], v[116:119], v[96:99], v[56:71]
    ds_read_b128 v[92:95], v9 offset:3072
    ds_read_b64_tr_b16 v[108:109], v16 offset:61440
    ds_read_b64_tr_b16 v[110:111], v16 offset:62464
    s_waitcnt lgkmcnt(8)
    v_mfma_f32_32x32x16_bf16 v[72:87], v[120:123], v[96:99], v[72:87]
    ds_read_b64_tr_b16 v[112:113], v17 offset:61440
    ds_read_b64_tr_b16 v[114:115], v17 offset:62464
    s_waitcnt lgkmcnt(7)
    v_mfma_f32_32x32x16_bf16 v[56:71], v[100:103], v[88:91], v[56:71]
    s_waitcnt lgkmcnt(0)
    s_barrier
    ds_read_b128 v[96:99], v9 offset:8192
    ds_read_b64_tr_b16 v[116:117], v18 offset:0
    v_mfma_f32_32x32x16_bf16 v[72:87], v[104:107], v[88:91], v[72:87]
    ds_read_b64_tr_b16 v[118:119], v18 offset:1024
    ds_read_b64_tr_b16 v[120:121], v19 offset:0
    ds_read_b64_tr_b16 v[122:123], v19 offset:1024
    v_mfma_f32_32x32x16_bf16 v[56:71], v[108:111], v[92:95], v[56:71]
    ds_read_b128 v[88:91], v9 offset:9216
    ds_read_b64_tr_b16 v[100:101], v18 offset:4096
    ds_read_b64_tr_b16 v[102:103], v18 offset:5120
    v_mfma_f32_32x32x16_bf16 v[72:87], v[112:115], v[92:95], v[72:87]
    ds_read_b64_tr_b16 v[104:105], v19 offset:4096
    ds_read_b64_tr_b16 v[106:107], v19 offset:5120
    s_waitcnt lgkmcnt(7)
    v_mfma_f32_32x32x16_bf16 v[56:71], v[116:119], v[96:99], v[56:71]
    ds_read_b128 v[92:95], v9 offset:10240
    ds_read_b64_tr_b16 v[108:109], v18 offset:8192
    ds_read_b64_tr_b16 v[110:111], v18 offset:9216
    s_waitcnt lgkmcnt(8)
    v_mfma_f32_32x32x16_bf16 v[72:87], v[120:123], v[96:99], v[72:87]
    ds_read_b64_tr_b16 v[112:113], v19 offset:8192
    ds_read_b64_tr_b16 v[114:115], v19 offset:9216
    s_waitcnt lgkmcnt(7)
    v_mfma_f32_32x32x16_bf16 v[56:71], v[100:103], v[88:91], v[56:71]
    ds_read_b128 v[96:99], v9 offset:11264
    ds_read_b64_tr_b16 v[116:117], v18 offset:12288
    ds_read_b64_tr_b16 v[118:119], v18 offset:13312
    s_waitcnt lgkmcnt(8)
    v_mfma_f32_32x32x16_bf16 v[72:87], v[104:107], v[88:91], v[72:87]
    ds_read_b64_tr_b16 v[120:121], v19 offset:12288
    ds_read_b64_tr_b16 v[122:123], v19 offset:13312
    s_waitcnt lgkmcnt(7)
    v_mfma_f32_32x32x16_bf16 v[56:71], v[108:111], v[92:95], v[56:71]
    s_waitcnt lgkmcnt(0)
    s_barrier
    ds_read_b128 v[88:91], v9 offset:16384
    ds_read_b64_tr_b16 v[100:101], v18 offset:16384
    v_mfma_f32_32x32x16_bf16 v[72:87], v[112:115], v[92:95], v[72:87]
    ds_read_b64_tr_b16 v[102:103], v18 offset:17408
    ds_read_b64_tr_b16 v[104:105], v19 offset:16384
    ds_read_b64_tr_b16 v[106:107], v19 offset:17408
    v_mfma_f32_32x32x16_bf16 v[56:71], v[116:119], v[96:99], v[56:71]
    ds_read_b128 v[92:95], v9 offset:17408
    ds_read_b64_tr_b16 v[108:109], v18 offset:20480
    ds_read_b64_tr_b16 v[110:111], v18 offset:21504
    v_mfma_f32_32x32x16_bf16 v[72:87], v[120:123], v[96:99], v[72:87]
    ds_read_b64_tr_b16 v[112:113], v19 offset:20480
    ds_read_b64_tr_b16 v[114:115], v19 offset:21504
    s_waitcnt lgkmcnt(7)
    v_mfma_f32_32x32x16_bf16 v[56:71], v[100:103], v[88:91], v[56:71]
    ds_read_b128 v[96:99], v9 offset:18432
    ds_read_b64_tr_b16 v[116:117], v18 offset:24576
    ds_read_b64_tr_b16 v[118:119], v18 offset:25600
    s_waitcnt lgkmcnt(8)
    v_mfma_f32_32x32x16_bf16 v[72:87], v[104:107], v[88:91], v[72:87]
    ds_read_b64_tr_b16 v[120:121], v19 offset:24576
    ds_read_b64_tr_b16 v[122:123], v19 offset:25600
    s_waitcnt lgkmcnt(7)
    v_mfma_f32_32x32x16_bf16 v[56:71], v[108:111], v[92:95], v[56:71]
    ds_read_b128 v[88:91], v9 offset:19456
    ds_read_b64_tr_b16 v[100:101], v18 offset:28672
    ds_read_b64_tr_b16 v[102:103], v18 offset:29696
    s_waitcnt lgkmcnt(8)
    v_mfma_f32_32x32x16_bf16 v[72:87], v[112:115], v[92:95], v[72:87]
    ds_read_b64_tr_b16 v[104:105], v19 offset:28672
    ds_read_b64_tr_b16 v[106:107], v19 offset:29696
    s_waitcnt lgkmcnt(7)
    v_mfma_f32_32x32x16_bf16 v[56:71], v[116:119], v[96:99], v[56:71]
    s_waitcnt vmcnt(0) lgkmcnt(0)
    s_barrier
    ds_read_b128 v[92:95], v9 offset:24576
    ds_read_b64_tr_b16 v[108:109], v18 offset:32768
    v_mfma_f32_32x32x16_bf16 v[72:87], v[120:123], v[96:99], v[72:87]
    ds_read_b64_tr_b16 v[110:111], v18 offset:33792
    ds_read_b64_tr_b16 v[112:113], v19 offset:32768
    ds_read_b64_tr_b16 v[114:115], v19 offset:33792
    v_mfma_f32_32x32x16_bf16 v[56:71], v[100:103], v[88:91], v[56:71]
    ds_read_b128 v[96:99], v9 offset:25600
    ds_read_b64_tr_b16 v[116:117], v18 offset:36864
    ds_read_b64_tr_b16 v[118:119], v18 offset:37888
    v_mfma_f32_32x32x16_bf16 v[72:87], v[104:107], v[88:91], v[72:87]
    ds_read_b64_tr_b16 v[120:121], v19 offset:36864
    ds_read_b64_tr_b16 v[122:123], v19 offset:37888
    s_waitcnt lgkmcnt(7)
    v_mfma_f32_32x32x16_bf16 v[56:71], v[108:111], v[92:95], v[56:71]
    ds_read_b128 v[88:91], v9 offset:26624
    ds_read_b64_tr_b16 v[100:101], v18 offset:40960
    ds_read_b64_tr_b16 v[102:103], v18 offset:41984
    s_waitcnt lgkmcnt(8)
    v_mfma_f32_32x32x16_bf16 v[72:87], v[112:115], v[92:95], v[72:87]
    ds_read_b64_tr_b16 v[104:105], v19 offset:40960
    ds_read_b64_tr_b16 v[106:107], v19 offset:41984
    s_waitcnt lgkmcnt(7)
    v_mfma_f32_32x32x16_bf16 v[56:71], v[116:119], v[96:99], v[56:71]
    ds_read_b128 v[92:95], v9 offset:27648
    ds_read_b64_tr_b16 v[108:109], v18 offset:45056
    ds_read_b64_tr_b16 v[110:111], v18 offset:46080
    s_waitcnt lgkmcnt(8)
    v_mfma_f32_32x32x16_bf16 v[72:87], v[120:123], v[96:99], v[72:87]
    ds_read_b64_tr_b16 v[112:113], v19 offset:45056
    ds_read_b64_tr_b16 v[114:115], v19 offset:46080
    s_waitcnt lgkmcnt(7)
    v_mfma_f32_32x32x16_bf16 v[56:71], v[100:103], v[88:91], v[56:71]
    s_waitcnt lgkmcnt(0)
    s_barrier
    ds_read_b128 v[96:99], v9 offset:32768
    ds_read_b64_tr_b16 v[116:117], v16 offset:0
    v_mfma_f32_32x32x16_bf16 v[72:87], v[104:107], v[88:91], v[72:87]
    ds_read_b64_tr_b16 v[118:119], v16 offset:1024
    ds_read_b64_tr_b16 v[120:121], v17 offset:0
    ds_read_b64_tr_b16 v[122:123], v17 offset:1024
    v_mfma_f32_32x32x16_bf16 v[56:71], v[108:111], v[92:95], v[56:71]
    ds_read_b128 v[88:91], v9 offset:33792
    ds_read_b64_tr_b16 v[100:101], v16 offset:4096
    ds_read_b64_tr_b16 v[102:103], v16 offset:5120
    v_mfma_f32_32x32x16_bf16 v[72:87], v[112:115], v[92:95], v[72:87]
    ds_read_b64_tr_b16 v[104:105], v17 offset:4096
    ds_read_b64_tr_b16 v[106:107], v17 offset:5120
    s_waitcnt lgkmcnt(7)
    v_mfma_f32_32x32x16_bf16 v[56:71], v[116:119], v[96:99], v[56:71]
    ds_read_b128 v[92:95], v9 offset:34816
    ds_read_b64_tr_b16 v[108:109], v16 offset:8192
    ds_read_b64_tr_b16 v[110:111], v16 offset:9216
    s_waitcnt lgkmcnt(8)
    v_mfma_f32_32x32x16_bf16 v[72:87], v[120:123], v[96:99], v[72:87]
    ds_read_b64_tr_b16 v[112:113], v17 offset:8192
    ds_read_b64_tr_b16 v[114:115], v17 offset:9216
    s_waitcnt lgkmcnt(7)
    v_mfma_f32_32x32x16_bf16 v[56:71], v[100:103], v[88:91], v[56:71]
    ds_read_b128 v[96:99], v9 offset:35840
    ds_read_b64_tr_b16 v[116:117], v16 offset:12288
    ds_read_b64_tr_b16 v[118:119], v16 offset:13312
    s_waitcnt lgkmcnt(8)
    v_mfma_f32_32x32x16_bf16 v[72:87], v[104:107], v[88:91], v[72:87]
    ds_read_b64_tr_b16 v[120:121], v17 offset:12288
    ds_read_b64_tr_b16 v[122:123], v17 offset:13312
    s_waitcnt lgkmcnt(7)
    v_mfma_f32_32x32x16_bf16 v[56:71], v[108:111], v[92:95], v[56:71]
    ds_read_b128 v[88:91], v9 offset:40960
    ds_read_b64_tr_b16 v[100:101], v16 offset:16384
    ds_read_b64_tr_b16 v[102:103], v16 offset:17408
    s_waitcnt lgkmcnt(8)
    v_mfma_f32_32x32x16_bf16 v[72:87], v[112:115], v[92:95], v[72:87]
    ds_read_b64_tr_b16 v[104:105], v17 offset:16384
    ds_read_b64_tr_b16 v[106:107], v17 offset:17408
    s_waitcnt lgkmcnt(7)
    v_mfma_f32_32x32x16_bf16 v[56:71], v[116:119], v[96:99], v[56:71]
    ds_read_b128 v[92:95], v9 offset:41984
    ds_read_b64_tr_b16 v[108:109], v16 offset:20480
    ds_read_b64_tr_b16 v[110:111], v16 offset:21504
    s_waitcnt lgkmcnt(8)
    v_mfma_f32_32x32x16_bf16 v[72:87], v[120:123], v[96:99], v[72:87]
    ds_read_b64_tr_b16 v[112:113], v17 offset:20480
    ds_read_b64_tr_b16 v[114:115], v17 offset:21504
    s_waitcnt lgkmcnt(7)
    v_mfma_f32_32x32x16_bf16 v[56:71], v[100:103], v[88:91], v[56:71]
    ds_read_b128 v[96:99], v9 offset:43008
    ds_read_b64_tr_b16 v[116:117], v16 offset:24576
    ds_read_b64_tr_b16 v[118:119], v16 offset:25600
    s_waitcnt lgkmcnt(8)
    v_mfma_f32_32x32x16_bf16 v[72:87], v[104:107], v[88:91], v[72:87]
    ds_read_b64_tr_b16 v[120:121], v17 offset:24576
    ds_read_b64_tr_b16 v[122:123], v17 offset:25600
    s_waitcnt lgkmcnt(7)
    v_mfma_f32_32x32x16_bf16 v[56:71], v[108:111], v[92:95], v[56:71]
    ds_read_b128 v[88:91], v9 offset:44032
    ds_read_b64_tr_b16 v[100:101], v16 offset:28672
    ds_read_b64_tr_b16 v[102:103], v16 offset:29696
    s_waitcnt lgkmcnt(8)
    v_mfma_f32_32x32x16_bf16 v[72:87], v[112:115], v[92:95], v[72:87]
    ds_read_b64_tr_b16 v[104:105], v17 offset:28672
    ds_read_b64_tr_b16 v[106:107], v17 offset:29696
    s_waitcnt lgkmcnt(7)
    v_mfma_f32_32x32x16_bf16 v[56:71], v[116:119], v[96:99], v[56:71]
    ds_read_b128 v[92:95], v9 offset:0
    ds_read_b64_tr_b16 v[108:109], v16 offset:32768
    ds_read_b64_tr_b16 v[110:111], v16 offset:33792
    s_waitcnt lgkmcnt(8)
    v_mfma_f32_32x32x16_bf16 v[72:87], v[120:123], v[96:99], v[72:87]
    ds_read_b64_tr_b16 v[112:113], v17 offset:32768
    ds_read_b64_tr_b16 v[114:115], v17 offset:33792
    s_waitcnt lgkmcnt(7)
    v_mfma_f32_32x32x16_bf16 v[56:71], v[100:103], v[88:91], v[56:71]
    ds_read_b128 v[96:99], v9 offset:1024
    ds_read_b64_tr_b16 v[116:117], v16 offset:36864
    ds_read_b64_tr_b16 v[118:119], v16 offset:37888
    s_waitcnt lgkmcnt(8)
    v_mfma_f32_32x32x16_bf16 v[72:87], v[104:107], v[88:91], v[72:87]
    ds_read_b64_tr_b16 v[120:121], v17 offset:36864
    ds_read_b64_tr_b16 v[122:123], v17 offset:37888
    s_waitcnt lgkmcnt(7)
    v_mfma_f32_32x32x16_bf16 v[56:71], v[108:111], v[92:95], v[56:71]
    ds_read_b128 v[88:91], v9 offset:2048
    ds_read_b64_tr_b16 v[100:101], v16 offset:40960
    ds_read_b64_tr_b16 v[102:103], v16 offset:41984
    s_waitcnt lgkmcnt(8)
    v_mfma_f32_32x32x16_bf16 v[72:87], v[112:115], v[92:95], v[72:87]
    ds_read_b64_tr_b16 v[104:105], v17 offset:40960
    ds_read_b64_tr_b16 v[106:107], v17 offset:41984
    s_waitcnt lgkmcnt(7)
    v_mfma_f32_32x32x16_bf16 v[56:71], v[116:119], v[96:99], v[56:71]
    ds_read_b128 v[92:95], v9 offset:3072
    ds_read_b64_tr_b16 v[108:109], v16 offset:45056
    ds_read_b64_tr_b16 v[110:111], v16 offset:46080
    s_waitcnt lgkmcnt(8)
    v_mfma_f32_32x32x16_bf16 v[72:87], v[120:123], v[96:99], v[72:87]
    ds_read_b64_tr_b16 v[112:113], v17 offset:45056
    ds_read_b64_tr_b16 v[114:115], v17 offset:46080
    s_waitcnt lgkmcnt(7)
    v_mfma_f32_32x32x16_bf16 v[56:71], v[100:103], v[88:91], v[56:71]
    s_waitcnt lgkmcnt(5)
    v_mfma_f32_32x32x16_bf16 v[72:87], v[104:107], v[88:91], v[72:87]
    s_waitcnt lgkmcnt(2)
    v_mfma_f32_32x32x16_bf16 v[56:71], v[108:111], v[92:95], v[56:71]
    s_waitcnt lgkmcnt(0)
    v_mfma_f32_32x32x16_bf16 v[72:87], v[112:115], v[92:95], v[72:87]
    s_nop 9
    s_cmp_eq_u32 s50, 2
    s_cbranch_scc1 P2_KEEPB
    v_cvt_pk_bf16_f32 v124, v56, v57
    v_cvt_pk_bf16_f32 v125, v58, v59
    v_cvt_pk_bf16_f32 v126, v60, v61
    v_cvt_pk_bf16_f32 v127, v62, v63
    v_cvt_pk_bf16_f32 v128, v64, v65
    v_cvt_pk_bf16_f32 v129, v66, v67
    v_cvt_pk_bf16_f32 v130, v68, v69
    v_cvt_pk_bf16_f32 v131, v70, v71
    v_permlane16_swap_b32 v124, v128
    v_permlane16_swap_b32 v125, v129
    v_permlane16_swap_b32 v126, v130
    v_permlane16_swap_b32 v127, v131
    buffer_store_dwordx4 v[124:127], v14, s[12:15], s55 offen offset:0 sc1
    buffer_store_dwordx4 v[128:131], v14, s[12:15], s55 offen offset:1024 sc1
    v_cvt_pk_bf16_f32 v132, v72, v73
    v_cvt_pk_bf16_f32 v133, v74, v75
    v_cvt_pk_bf16_f32 v134, v76, v77
    v_cvt_pk_bf16_f32 v135, v78, v79
    v_cvt_pk_bf16_f32 v136, v80, v81
    v_cvt_pk_bf16_f32 v137, v82, v83
    v_cvt_pk_bf16_f32 v138, v84, v85
    v_cvt_pk_bf16_f32 v139, v86, v87
    v_permlane16_swap_b32 v132, v136
    v_permlane16_swap_b32 v133, v137
    v_permlane16_swap_b32 v134, v138
    v_permlane16_swap_b32 v135, v139
    buffer_store_dwordx4 v[132:135], v14, s[12:15], s55 offen offset:2048 sc1
    buffer_store_dwordx4 v[136:139], v14, s[12:15], s55 offen offset:3072 sc1
P2_KEEPB:
    s_cmp_lg_u32 s50, 0
    s_cbranch_scc1 P3_NOWN0
    ds_write_b128 v20, v[24:27] offset:0
    ds_write_b128 v21, v[28:31] offset:0
    ds_write_b128 v22, v[32:35] offset:0
    ds_write_b128 v23, v[36:39] offset:0
    ds_write_b128 v20, v[40:43] offset:128
    ds_write_b128 v21, v[44:47] offset:128
    ds_write_b128 v22, v[48:51] offset:128
    ds_write_b128 v23, v[52:55] offset:128
P3_NOWN0:
    s_cmp_lg_u32 s50, 2
    s_cbranch_scc1 P3_NOWN1
    ds_write_b128 v20, v[56:59] offset:0
    ds_write_b128 v21, v[60:63] offset:0
    ds_write_b128 v22, v[64:67] offset:0
    ds_write_b128 v23, v[68:71] offset:0
    ds_write_b128 v20, v[72:75] offset:128
    ds_write_b128 v21, v[76:79] offset:128
    ds_write_b128 v22, v[80:83] offset:128
    ds_write_b128 v23, v[84:87] offset:128
P3_NOWN1:
    v_and_b32 v2, 31, v1
    s_lshl_b32 s3, s64, 6
    v_add_u32 v2, s3, v2
    v_cvt_f32_u32 v148, v2
    s_and_b32 s3, s37, 1
    s_lshl_b32 s3, s3, 7
    s_lshr_b32 s40, s37, 1
    s_add_u32 s3, s3, s40
    s_add_u32 s3, s3, 1
    v_lshl_add_u32 v2, v5, 3, s3
    v_cvt_f32_u32 v3, v2
    v_mul_f32 v148, 0x3b800000, v148
    v_mul_f32 v3, 0.5, v3
    v_add_f32 v149, 0x3e000000, v148
    v_cmp_eq_u32 vcc, 138, v2
    v_mov_b32 v152, 1.0
    v_mul_f32 v146, v3, v148
    v_mul_f32 v150, 0x40a00000, v148
    v_mul_f32 v147, v3, v149
    v_mul_f32 v151, 0x40a00000, v149
    v_cndmask_b32 v152, v152, 0.5, vcc
    v_cos_f32 v142, v146
    v_sin_f32 v143, v146
    v_add_f32 v146, v146, v148
    v_cvt_pk_bf16_f32 v192, v142, -v143
    v_cos_f32 v144, v147
    v_sin_f32 v145, v147
    v_add_f32 v147, v147, v149
    v_cvt_pk_bf16_f32 v224, v144, -v145
    v_cos_f32 v142, v146
    v_sin_f32 v143, v146
    v_add_f32 v146, v146, v148
    v_cvt_pk_bf16_f32 v193, v142, -v143
    v_cos_f32 v144, v147
    v_sin_f32 v145, v147
    v_add_f32 v147, v147, v149
    v_cvt_pk_bf16_f32 v225, v144, -v145
    v_cos_f32 v142, v146
    v_sin_f32 v143, v146
    v_add_f32 v146, v146, v148
    v_cvt_pk_bf16_f32 v194, v142, -v143
    v_cos_f32 v144, v147
    v_sin_f32 v145, v147
    v_add_f32 v147, v147, v149
    v_cvt_pk_bf16_f32 v226, v144, -v145
    v_cos_f32 v142, v146
    v_sin_f32 v143, v146
    v_add_f32 v146, v146, v150
    v_cvt_pk_bf16_f32 v195, v142, -v143
    v_cos_f32 v144, v147
    v_sin_f32 v145, v147
    v_add_f32 v147, v147, v151
    v_cvt_pk_bf16_f32 v227, v144, -v145
    v_cos_f32 v142, v146
    v_sin_f32 v143, v146
    v_add_f32 v146, v146, v148
    v_cvt_pk_bf16_f32 v196, v142, -v143
    v_cos_f32 v144, v147
    v_sin_f32 v145, v147
    v_add_f32 v147, v147, v149
    v_cvt_pk_bf16_f32 v228, v144, -v145
    v_cos_f32 v142, v146
    v_sin_f32 v143, v146
    v_add_f32 v146, v146, v148
    v_cvt_pk_bf16_f32 v197, v142, -v143
    v_cos_f32 v144, v147
    v_sin_f32 v145, v147
    v_add_f32 v147, v147, v149
    v_cvt_pk_bf16_f32 v229, v144, -v145
    v_cos_f32 v142, v146
    v_sin_f32 v143, v146
    v_add_f32 v146, v146, v148
    v_cvt_pk_bf16_f32 v198, v142, -v143
    v_cos_f32 v144, v147
    v_sin_f32 v145, v147
    v_add_f32_e64 v147, v147, v149
    v_cvt_pk_bf16_f32 v230, v144, -v145
    v_cos_f32 v142, v146
    v_sin_f32 v143, v146
    v_add_f32 v146, v146, v150
    v_cvt_pk_bf16_f32 v199, v142, -v143
    v_cos_f32 v144, v147
    v_sin_f32 v145, v147
    v_add_f32 v147, v147, v151
    v_cvt_pk_bf16_f32 v231, v144, -v145
    v_cos_f32 v142, v146
    v_sin_f32 v143, v146
    v_add_f32_e64 v146, v146, v148
    v_cvt_pk_bf16_f32 v200, v142, -v143
    v_cos_f32 v144, v147
    v_sin_f32 v145, v147
    v_add_f32 v147, v147, v149
    v_cvt_pk_bf16_f32 v232, v144, -v145
    v_cos_f32 v142, v146
    v_sin_f32 v143, v146
    v_add_f32 v146, v146, v148
    v_cvt_pk_bf16_f32 v201, v142, -v143
    v_cos_f32 v144, v147
    v_sin_f32 v145, v147
    v_add_f32_e64 v147, v147, v149
    v_cvt_pk_bf16_f32 v233, v144, -v145
    v_cos_f32 v142, v146
    v_sin_f32 v143, v146
    v_add_f32 v146, v146, v148
    v_cvt_pk_bf16_f32 v202, v142, -v143
    v_cos_f32 v144, v147
    v_sin_f32 v145, v147
    v_add_f32 v147, v147, v149
    v_cvt_pk_bf16_f32 v234, v144, -v145
    v_cos_f32 v142, v146
    v_sin_f32 v143, v146
    v_add_f32_e64 v146, v146, v150
    v_cvt_pk_bf16_f32 v203, v142, -v143
    v_cos_f32 v144, v147
    v_sin_f32 v145, v147
    v_add_f32 v147, v147, v151
    v_cvt_pk_bf16_f32 v235, v144, -v145
    v_cos_f32 v142, v146
    v_sin_f32 v143, v146
    v_add_f32 v146, v146, v148
    v_cvt_pk_bf16_f32 v204, v142, -v143
    v_cos_f32 v144, v147
    v_sin_f32 v145, v147
    v_add_f32_e64 v147, v147, v149
    v_cvt_pk_bf16_f32 v236, v144, -v145
    v_cos_f32 v142, v146
    v_sin_f32 v143, v146
    v_add_f32 v146, v146, v148
    v_cvt_pk_bf16_f32 v205, v142, -v143
    v_cos_f32 v144, v147
    v_sin_f32 v145, v147
    v_add_f32 v147, v147, v149
    v_cvt_pk_bf16_f32 v237, v144, -v145
    v_cos_f32 v142, v146
    v_sin_f32 v143, v146
    v_add_f32_e64 v146, v146, v148
    v_cvt_pk_bf16_f32 v206, v142, -v143
    v_cos_f32 v144, v147
    v_sin_f32 v145, v147
    v_add_f32 v147, v147, v149
    s_waitcnt vmcnt(0)
    s_lshl_b32 s3, s2, 2
    s_add_u32 s3, s3, s37
    s_lshl_b32 s3, s3, 7
    s_add_u32 s3, s3, 22478848
    v_lshlrev_b32 v140, 2, v1
    v_mov_b32_e64 v141, s66
    s_mov_b64 exec, 0xffffffff
    buffer_store_dword v141, v140, s[12:15], s3 offen sc1
    s_mov_b64 exec, -1
    s_barrier
    v_cvt_pk_bf16_f32 v238, v144, -v145
    v_cos_f32 v142, v146
    v_sin_f32 v143, v146
    v_add_f32 v146, v146, v150
    v_cvt_pk_bf16_f32 v207, v142, -v143
    v_cos_f32 v144, v147
    v_sin_f32 v145, v147
    v_add_f32 v147, v147, v151
    v_cvt_pk_bf16_f32 v239, v144, -v145
    v_cos_f32 v142, v146
    v_sin_f32 v143, v146
    v_add_f32 v146, v146, v148
    v_cvt_pk_bf16_f32 v208, v142, -v143
    v_cos_f32 v144, v147
    v_sin_f32 v145, v147
    v_add_f32 v147, v147, v149
    v_cvt_pk_bf16_f32 v240, v144, -v145
    v_cos_f32 v142, v146
    v_sin_f32 v143, v146
    v_add_f32 v146, v146, v148
    v_cvt_pk_bf16_f32 v209, v142, -v143
    v_cos_f32 v144, v147
    v_sin_f32 v145, v147
    v_add_f32 v147, v147, v149
    v_cvt_pk_bf16_f32 v241, v144, -v145
    v_cos_f32 v142, v146
    v_sin_f32 v143, v146
    v_add_f32 v146, v146, v148
    v_cvt_pk_bf16_f32 v210, v142, -v143
    v_cos_f32 v144, v147
    v_sin_f32 v145, v147
    v_add_f32 v147, v147, v149
    v_cvt_pk_bf16_f32 v242, v144, -v145
    v_cos_f32 v142, v146
    v_sin_f32 v143, v146
    v_add_f32 v146, v146, v150
    v_cvt_pk_bf16_f32 v211, v142, -v143
    v_cos_f32 v144, v147
    v_sin_f32 v145, v147
    v_add_f32 v147, v147, v151
    v_cvt_pk_bf16_f32 v243, v144, -v145
    v_cos_f32 v142, v146
    v_sin_f32 v143, v146
    v_add_f32 v146, v146, v148
    v_cvt_pk_bf16_f32 v212, v142, -v143
    v_cos_f32 v144, v147
    v_sin_f32 v145, v147
    v_add_f32 v147, v147, v149
    v_cvt_pk_bf16_f32 v244, v144, -v145
    v_cos_f32 v142, v146
    v_sin_f32 v143, v146
    v_add_f32 v146, v146, v148
    v_cvt_pk_bf16_f32 v213, v142, -v143
    v_cos_f32 v144, v147
    v_sin_f32 v145, v147
    v_add_f32 v147, v147, v149
    v_cvt_pk_bf16_f32 v245, v144, -v145
    v_cos_f32 v142, v146
    v_sin_f32 v143, v146
    v_add_f32_e64 v146, v146, v148
    v_cvt_pk_bf16_f32 v214, v142, -v143
    v_cos_f32 v144, v147
    v_sin_f32 v145, v147
    v_add_f32 v147, v147, v149
    v_cvt_pk_bf16_f32 v246, v144, -v145
    v_cos_f32 v142, v146
    v_sin_f32 v143, v146
    v_add_f32 v146, v146, v150
    v_cvt_pk_bf16_f32 v215, v142, -v143
    v_cos_f32 v144, v147
    v_sin_f32 v145, v147
    v_add_f32_e64 v147, v147, v151
    v_cvt_pk_bf16_f32 v247, v144, -v145
    v_cos_f32 v142, v146
    v_sin_f32 v143, v146
    v_add_f32 v146, v146, v148
    v_cvt_pk_bf16_f32 v216, v142, -v143
    v_cos_f32 v144, v147
    v_sin_f32 v145, v147
    v_add_f32 v147, v147, v149
    v_cvt_pk_bf16_f32 v248, v144, -v145
    v_cos_f32 v142, v146
    v_sin_f32 v143, v146
    v_add_f32_e64 v146, v146, v148
    v_cvt_pk_bf16_f32 v217, v142, -v143
    v_cos_f32 v144, v147
    v_sin_f32 v145, v147
    v_add_f32 v147, v147, v149
    v_cvt_pk_bf16_f32 v249, v144, -v145
    v_cos_f32 v142, v146
    v_sin_f32 v143, v146
    v_add_f32 v146, v146, v148
    v_cvt_pk_bf16_f32 v218, v142, -v143
    v_cos_f32 v144, v147
    v_sin_f32 v145, v147
    v_add_f32_e64 v147, v147, v149
    v_cvt_pk_bf16_f32 v250, v144, -v145
    v_cos_f32 v142, v146
    v_sin_f32 v143, v146
    v_add_f32 v146, v146, v150
    v_cvt_pk_bf16_f32 v219, v142, -v143
    v_cos_f32 v144, v147
    v_sin_f32 v145, v147
    v_add_f32 v147, v147, v151
    v_cvt_pk_bf16_f32 v251, v144, -v145
    v_cos_f32 v142, v146
    v_sin_f32 v143, v146
    v_add_f32_e64 v146, v146, v148
    v_cvt_pk_bf16_f32 v220, v142, -v143
    v_cos_f32 v144, v147
    v_sin_f32 v145, v147
    v_add_f32 v147, v147, v149
    v_cvt_pk_bf16_f32 v252, v144, -v145
    v_cos_f32 v142, v146
    v_sin_f32 v143, v146
    v_add_f32 v146, v146, v148
    v_cvt_pk_bf16_f32 v221, v142, -v143
    v_cos_f32 v144, v147
    v_sin_f32 v145, v147
    v_add_f32_e64 v147, v147, v149
    v_cvt_pk_bf16_f32 v253, v144, -v145
    v_cos_f32 v142, v146
    v_sin_f32 v143, v146
    v_add_f32 v146, v146, v148
    v_cvt_pk_bf16_f32 v222, v142, -v143
    v_cos_f32 v144, v147
    v_sin_f32 v145, v147
    v_add_f32 v147, v147, v149
    v_cvt_pk_bf16_f32 v254, v144, -v145
    v_cos_f32 v142, v146
    v_sin_f32 v143, v146
    v_mul_f32_e64 v142, v142, v152
    v_cvt_pk_bf16_f32 v223, v142, -v143
    v_cos_f32 v144, v147
    v_sin_f32 v145, v147
    v_mul_f32 v144, v144, v152
    v_cvt_pk_bf16_f32 v255, v144, -v145
    v_bfe_u32 v3, v1, 2, 2
    v_lshl_add_u32 v2, v5, 3, v3
    v_lshlrev_b32 v2, 6, v2
    v_bfe_u32 v4, v1, 4, 1
    v_lshl_add_u32 v2, v4, 5, v2
    v_and_b32 v4, 3, v1
    v_lshl_add_u32 v2, v4, 3, v2
    s_lshl_b32 s3, s37, 13
    s_add_u32 s40, s3, 49152
    v_add_u32 v153, s40, v2
    v_and_b32 v2, 31, v1
    s_add_u32 s3, s3, 0
    v_lshl_add_u32 v2, v2, 8, s3
    v_and_b32 v4, 7, v1
    v_xor_b32 v4, v4, v5
    v_xor_b32 v6, 0, v4
    v_lshl_add_u32 v154, v6, 4, v2
    v_xor_b32 v6, 2, v4
    v_lshl_add_u32 v155, v6, 4, v2
    v_xor_b32 v6, 4, v4
    v_lshl_add_u32 v156, v6, 4, v2
    v_xor_b32_e64 v6, 6, v4
    v_lshl_add_u32 v157, v6, 4, v2
    s_waitcnt lgkmcnt(0)
    s_barrier
    ds_read_b64_tr_b16 v[88:89], v153 offset:0
    ds_read_b64_tr_b16 v[90:91], v153 offset:256
    ds_read_b64_tr_b16 v[92:93], v153 offset:1024
    ds_read_b64_tr_b16 v[94:95], v153 offset:1280
    ds_read_b64_tr_b16 v[96:97], v153 offset:2048
    ds_read_b64_tr_b16 v[98:99], v153 offset:2304
    ds_read_b64_tr_b16 v[100:101], v153 offset:3072
    ds_read_b64_tr_b16 v[102:103], v153 offset:3328
    s_waitcnt lgkmcnt(6)
    v_mfma_f32_32x32x16_bf16 v[160:175], v[192:195], v[88:91], 0
    ds_read_b64_tr_b16 v[104:105], v153 offset:4096
    v_mfma_f32_32x32x16_bf16 v[176:191], v[224:227], v[88:91], 0
    ds_read_b64_tr_b16 v[106:107], v153 offset:4352
    s_waitcnt lgkmcnt(6)
    v_mfma_f32_32x32x16_bf16 v[160:175], v[196:199], v[92:95], v[160:175]
    ds_read_b64_tr_b16 v[108:109], v153 offset:5120
    v_mfma_f32_32x32x16_bf16 v[176:191], v[228:231], v[92:95], v[176:191]
    ds_read_b64_tr_b16 v[110:111], v153 offset:5376
    s_waitcnt lgkmcnt(6)
    v_mfma_f32_32x32x16_bf16 v[160:175], v[200:203], v[96:99], v[160:175]
    ds_read_b64_tr_b16 v[112:113], v153 offset:6144
    v_mfma_f32_32x32x16_bf16 v[176:191], v[232:235], v[96:99], v[176:191]
    ds_read_b64_tr_b16 v[114:115], v153 offset:6400
    s_waitcnt lgkmcnt(6)
    v_mfma_f32_32x32x16_bf16 v[160:175], v[204:207], v[100:103], v[160:175]
    ds_read_b64_tr_b16 v[116:117], v153 offset:7168
    v_mfma_f32_32x32x16_bf16 v[176:191], v[236:239], v[100:103], v[176:191]
    ds_read_b64_tr_b16 v[118:119], v153 offset:7424
    s_waitcnt lgkmcnt(6)
    v_mfma_f32_32x32x16_bf16 v[160:175], v[208:211], v[104:107], v[160:175]
    v_mfma_f32_32x32x16_bf16 v[176:191], v[240:243], v[104:107], v[176:191]
    s_waitcnt lgkmcnt(4)
    v_mfma_f32_32x32x16_bf16 v[160:175], v[212:215], v[108:111], v[160:175]
    v_mfma_f32_32x32x16_bf16 v[176:191], v[244:247], v[108:111], v[176:191]
    s_waitcnt lgkmcnt(2)
    v_mfma_f32_32x32x16_bf16 v[160:175], v[216:219], v[112:115], v[160:175]
    v_mfma_f32_32x32x16_bf16 v[176:191], v[248:251], v[112:115], v[176:191]
    s_waitcnt lgkmcnt(0)
    v_mfma_f32_32x32x16_bf16 v[160:175], v[220:223], v[116:119], v[160:175]
    v_mfma_f32_32x32x16_bf16 v[176:191], v[252:255], v[116:119], v[176:191]
    s_nop 10
    ds_write_b128 v154, v[160:163] offset:0
    ds_write_b128 v155, v[164:167] offset:0
    ds_write_b128 v156, v[168:171] offset:0
    ds_write_b128 v157, v[172:175] offset:0
    ds_write_b128 v154, v[176:179] offset:128
    ds_write_b128 v155, v[180:183] offset:128
    ds_write_b128 v156, v[184:187] offset:128
    ds_write_b128 v157, v[188:191] offset:128
    s_waitcnt lgkmcnt(0)
    s_barrier
    s_endpgm
P2_LOADER:
    s_add_u32 m0, s44, 114688
    s_nop 0
    buffer_load_dwordx4 v9, s[12:15], s60 offen offset:0 sc1 lds
    buffer_load_dwordx4 v9, s[12:15], s60 offen offset:1024 sc1 lds
    s_add_u32 s60, s60, 4096
    s_add_u32 m0, s44, 122880
    s_nop 0
    buffer_load_dwordx4 v9, s[12:15], s60 offen offset:0 sc1 lds
    buffer_load_dwordx4 v9, s[12:15], s60 offen offset:1024 sc1 lds
    s_add_u32 s60, s60, 4096
    s_add_u32 m0, s44, 131072
    s_nop 0
    buffer_load_dwordx4 v9, s[12:15], s60 offen offset:0 sc1 lds
    buffer_load_dwordx4 v9, s[12:15], s60 offen offset:1024 sc1 lds
    s_add_u32 s60, s60, 4096
    s_add_u32 m0, s44, 155648
    s_nop 0
    buffer_load_dwordx4 v9, s[12:15], s60 offen offset:0 sc1 lds
    buffer_load_dwordx4 v9, s[12:15], s60 offen offset:1024 sc1 lds
    s_add_u32 s60, s60, 4096
    s_add_u32 m0, s51, 98304
    s_nop 0
    buffer_load_dwordx4 v10, s[16:19], s61 offen offset:0 lds
    buffer_load_dwordx4 v11, s[16:19], s61 offen offset:1024 lds
    buffer_load_dwordx4 v12, s[16:19], s61 offen offset:2048 lds
    buffer_load_dwordx4 v13, s[16:19], s61 offen offset:3072 lds
    s_add_u32 s61, s61, 65536
    s_waitcnt vmcnt(10)
    s_barrier
    s_mov_b64 exec, 16777215
    buffer_load_dword v17, v14, s[12:15], 0 offen sc1
    s_mov_b64 exec, -1
    s_add_u32 m0, s51, 0
    s_nop 0
    buffer_load_dwordx4 v10, s[16:19], s61 offen offset:0 lds
    buffer_load_dwordx4 v11, s[16:19], s61 offen offset:1024 lds
    buffer_load_dwordx4 v12, s[16:19], s61 offen offset:2048 lds
    buffer_load_dwordx4 v13, s[16:19], s61 offen offset:3072 lds
    s_add_u32 s61, s61, 65536
    s_waitcnt vmcnt(13)
    s_barrier
    s_add_u32 m0, s44, 114688
    s_nop 0
    buffer_load_dwordx4 v9, s[12:15], s60 offen offset:0 sc1 lds
    buffer_load_dwordx4 v9, s[12:15], s60 offen offset:1024 sc1 lds
    s_add_u32 s60, s60, 4096
    s_add_u32 m0, s51, 16384
    s_nop 0
    buffer_load_dwordx4 v10, s[16:19], s61 offen offset:0 lds
    buffer_load_dwordx4 v11, s[16:19], s61 offen offset:1024 lds
    buffer_load_dwordx4 v12, s[16:19], s61 offen offset:2048 lds
    buffer_load_dwordx4 v13, s[16:19], s61 offen offset:3072 lds
    s_add_u32 s61, s61, 65536
    s_waitcnt vmcnt(17)
    s_barrier
    s_add_u32 m0, s44, 122880
    s_nop 0
    buffer_load_dwordx4 v9, s[12:15], s60 offen offset:0 sc1 lds
    buffer_load_dwordx4 v9, s[12:15], s60 offen offset:1024 sc1 lds
    s_add_u32 s60, s60, 4096
    s_add_u32 m0, s51, 32768
    s_nop 0
    buffer_load_dwordx4 v10, s[16:19], s61 offen offset:0 lds
    buffer_load_dwordx4 v11, s[16:19], s61 offen offset:1024 lds
    buffer_load_dwordx4 v12, s[16:19], s61 offen offset:2048 lds
    buffer_load_dwordx4 v13, s[16:19], s61 offen offset:3072 lds
    s_add_u32 s61, s61, -393216
    s_waitcnt vmcnt(21)
    s_waitcnt vmcnt(17)
    s_barrier
    s_add_u32 m0, s44, 131072
    s_nop 0
    buffer_load_dwordx4 v9, s[12:15], s60 offen offset:0 sc1 lds
    buffer_load_dwordx4 v9, s[12:15], s60 offen offset:1024 sc1 lds
    s_add_u32 s60, s60, 204800
    s_waitcnt vmcnt(0)
    s_barrier
    s_cmp_lg_u32 s37, 2
    s_cbranch_scc1 P2_F1B
    s_lshl_b32 s3, s2, 7
    s_add_u32 s3, s3, 22806528
    v_lshlrev_b32 v2, 2, v1
    v_mov_b32 v4, s66
    s_mov_b64 exec, 0xffffffff
    buffer_store_dword v4, v2, s[12:15], s3 offen sc1
    s_mov_b64 exec, -1
P2_F1B:
    s_mov_b64 exec, 16777215
    v_cmp_ne_u32 vcc, s66, v17
    s_cbranch_vccz P2_FX_END0
    s_mov_b32 s67, 0
P2_FX_SPIN0:
    s_mov_b64 exec, vcc
    s_sleep 4
    buffer_load_dword v17, v14, s[12:15], 0 offen sc1
    s_add_u32 s67, s67, 1
    s_cmp_gt_u32 s67, 20000
    s_waitcnt vmcnt(0)
    s_cbranch_scc1 P2_FX_END0
    v_cmp_ne_u32 vcc, s66, v17
    s_cbranch_vccnz P2_FX_SPIN0
P2_FX_END0:
    s_mov_b64 exec, -1
    s_add_u32 m0, s44, 139264
    s_nop 0
    buffer_load_dwordx4 v9, s[12:15], s47 offen offset:0 sc1 lds
    buffer_load_dwordx4 v9, s[12:15], s47 offen offset:1024 sc1 lds
    s_add_u32 m0, s44, 147456
    s_nop 0
    buffer_load_dwordx4 v9, s[12:15], s48 offen offset:0 sc1 lds
    buffer_load_dwordx4 v9, s[12:15], s48 offen offset:1024 sc1 lds
    v_add_u32 v18, 32768, v18
    s_waitcnt vmcnt(0)
    s_barrier
    s_mov_b64 exec, 15
    buffer_load_dword v15, v18, s[12:15], 0 offen sc1
    s_waitcnt vmcnt(0)
    v_cmp_ne_u32 vcc, s66, v15
    s_cbranch_vccz P2_FB_END0
    s_mov_b32 s67, 0
P2_FB_SPIN0:
    s_mov_b64 exec, vcc
    s_sleep 4
    buffer_load_dword v15, v18, s[12:15], 0 offen sc1
    s_add_u32 s67, s67, 1
    s_cmp_gt_u32 s67, 20000
    s_waitcnt vmcnt(0)
    s_cbranch_scc1 P2_FB_END0
    v_cmp_ne_u32 vcc, s66, v15
    s_cbranch_vccnz P2_FB_SPIN0
P2_FB_END0:
    s_mov_b64 exec, -1
    s_add_u32 m0, s44, 114688
    s_nop 0
    buffer_load_dwordx4 v9, s[12:15], s60 offen offset:0 sc1 lds
    buffer_load_dwordx4 v9, s[12:15], s60 offen offset:1024 sc1 lds
    s_add_u32 s60, s60, 4096
    s_add_u32 m0, s44, 122880
    s_nop 0
    buffer_load_dwordx4 v9, s[12:15], s60 offen offset:0 sc1 lds
    buffer_load_dwordx4 v9, s[12:15], s60 offen offset:1024 sc1 lds
    s_add_u32 s60, s60, 4096
    s_add_u32 m0, s44, 131072
    s_nop 0
    buffer_load_dwordx4 v9, s[12:15], s60 offen offset:0 sc1 lds
    buffer_load_dwordx4 v9, s[12:15], s60 offen offset:1024 sc1 lds
    s_add_u32 s60, s60, 4096
    s_barrier
    s_add_u32 m0, s44, 139264
    s_nop 0
    buffer_load_dwordx4 v9, s[12:15], s60 offen offset:0 sc1 lds
    buffer_load_dwordx4 v9, s[12:15], s60 offen offset:1024 sc1 lds
    s_add_u32 s60, s60, 4096
    s_add_u32 m0, s44, 147456
    s_nop 0
    buffer_load_dwordx4 v9, s[12:15], s60 offen offset:0 sc1 lds
    buffer_load_dwordx4 v9, s[12:15], s60 offen offset:1024 sc1 lds
    s_add_u32 s60, s60, 4096
    s_waitcnt vmcnt(8)
    s_barrier
    s_add_u32 m0, s44, 155648
    s_nop 0
    buffer_load_dwordx4 v9, s[12:15], s60 offen offset:0 sc1 lds
    buffer_load_dwordx4 v9, s[12:15], s60 offen offset:1024 sc1 lds
    s_add_u32 s60, s60, 4096
    s_waitcnt vmcnt(8)
    s_barrier
    s_add_u32 m0, s44, 114688
    s_nop 0
    buffer_load_dwordx4 v9, s[12:15], s60 offen offset:0 sc1 lds
    buffer_load_dwordx4 v9, s[12:15], s60 offen offset:1024 sc1 lds
    s_add_u32 s60, s60, -24576
    s_waitcnt vmcnt(8)
    s_barrier
    s_waitcnt vmcnt(6)
    s_barrier
    s_cmp_lg_u32 s37, 0
    s_cbranch_scc1 P2_F3
    s_lshl_b32 s3, s2, 7
    s_add_u32 s3, s3, 22740992
    v_lshlrev_b32 v2, 2, v1
    v_mov_b32 v4, s66
    s_mov_b64 exec, 0xffffffff
    buffer_store_dword v4, v2, s[12:15], s3 offen sc1
    s_mov_b64 exec, -1
P2_F3:
    s_cmp_lg_u32 s37, 1
    s_cbranch_scc1 P2_F2A
    s_lshl_b32 s3, s2, 9
    s_add_u32 s3, s3, 22347776
    v_lshlrev_b32 v2, 3, v1
    v_mov_b32 v4, s66
    v_mov_b32 v5, s66
    buffer_store_dwordx2 v[4:5], v2, s[12:15], s3 offen sc1
P2_F2A:
    s_lshl_b32 s51, s37, 13
    s_add_u32 s51, s51, 49152
    v_and_b32 v2, 3, v1
    v_lshlrev_b32_e64 v2, 4, v2
    v_bfe_u32 v4, v1, 2, 1
    v_lshl_add_u32 v2, v4, 12, v2
    v_lshrrev_b32 v3, 3, v1
    v_lshl_add_u32 v20, v3, 14, v2
    v_add_u32 v21, 130048, v20
    v_add_u32 v22, 260096, v20
    v_add_u32 v23, 390144, v20
    s_and_b32 s3, s37, 1
    s_lshl_b32 s3, s3, 7
    s_lshr_b32 s40, s37, 1
    s_add_u32 s3, s3, s40
    s_lshl_b32 s41, s3, 7
    s_add_u32 s41, s41, 22740992
    v_lshl_add_u32 v14, v1, 8, s41
    s_lshl_b32 s3, s3, 13
    s_lshl_b32 s40, s65, 6
    s_add_u32 s3, s3, s40
    s_add_u32 s60, s3, 11534336
    s_waitcnt vmcnt(0)
    s_barrier
    buffer_load_dword v15, v14, s[12:15], 0 offen sc1
    s_waitcnt vmcnt(0)
    v_cmp_ne_u32 vcc, s66, v15
    s_cbranch_vccz P3_FY_END0
    s_mov_b32 s67, 0
P3_FY_SPIN0:
    s_mov_b64 exec, vcc
    s_sleep 4
    buffer_load_dword v15, v14, s[12:15], 0 offen sc1
    s_add_u32 s67, s67, 1
    s_cmp_gt_u32 s67, 20000
    s_waitcnt vmcnt(0)
    s_cbranch_scc1 P3_FY_END0
    v_cmp_ne_u32 vcc, s66, v15
    s_cbranch_vccnz P3_FY_SPIN0
P3_FY_END0:
    s_mov_b64 exec, -1
    s_load_dwordx2 s[30:31], s[0:1], 48
    s_add_u32 m0, s51, 0
    s_nop 0
    buffer_load_dwordx4 v20, s[12:15], s60 offen offset:0 sc1 lds
    buffer_load_dwordx4 v21, s[12:15], s60 offen offset:1024 sc1 lds
    buffer_load_dwordx4 v22, s[12:15], s60 offen offset:2048 sc1 lds
    buffer_load_dwordx4 v23, s[12:15], s60 offen offset:3072 sc1 lds
    s_add_u32 s60, s60, 524288
    s_add_u32 m0, s51, 4096
    s_nop 0
    buffer_load_dwordx4 v20, s[12:15], s60 offen offset:0 sc1 lds
    buffer_load_dwordx4 v21, s[12:15], s60 offen offset:1024 sc1 lds
    buffer_load_dwordx4 v22, s[12:15], s60 offen offset:2048 sc1 lds
    buffer_load_dwordx4 v23, s[12:15], s60 offen offset:3072 sc1 lds
    s_mov_b64 s[4:5], s[24:25]
    s_mov_b32 s6, 2097152
    s_mov_b32 s7, 0x20000
    s_waitcnt lgkmcnt(0)
    s_mov_b64 s[16:17], s[30:31]
    s_mov_b32 s18, 2097152
    s_mov_b32 s19, 0x20000
    v_lshrrev_b32 v5, 5, v1
    v_bfe_u32 v3, v1, 3, 2
    v_lshl_add_u32 v2, v5, 4, v3
    v_and_b32 v4, 7, v1
    v_lshlrev_b32 v6, 4, v4
    v_lshl_add_u32 v24, v2, 10, v6
    s_lshr_b32 s3, s33, 2
    s_lshl_b32 s3, s3, 2
    s_add_u32 s3, s3, s32
    s_lshl_b32 s3, s3, 2
    s_add_u32 s3, s3, s37
    s_lshl_b32 s3, s3, 3
    s_and_b32 s40, s33, 3
    s_add_u32 s3, s3, s40
    s_lshl_b32 s3, s3, 5
    s_add_u32 s3, s3, s64
    s_lshl_b32 s45, s3, 7
    s_lshl_b32 s3, s65, 3
    s_add_u32 s3, s3, s64
    s_lshl_b32 s3, s3, 3
    s_add_u32 s3, s3, s37
    s_lshl_b32 s3, s3, 9
    s_add_u32 s43, s3, 13631488
    v_lshrrev_b32 v2, 3, v1
    v_and_b32 v3, 3, v1
    v_lshlrev_b32 v6, 4, v3
    v_lshl_add_u32 v6, v2, 6, v6
    v_bfe_u32 v7, v1, 2, 1
    v_lshl_add_u32 v25, v7, 11, v6
    v_max_u32 v3, 1, v3
    v_add_u32 v3, s32, v3
    v_and_b32 v3, 3, v3
    s_andn2_b32 s3, s2, 6
    s_lshl_b32 s3, s3, 2
    s_and_b32 s40, s32, 1
    s_lshl_b32 s40, s40, 1
    s_add_u32 s3, s3, s40
    s_lshr_b32 s40, s32, 1
    s_lshl_b32 s40, s40, 10
    s_add_u32 s3, s3, s40
    s_lshl_b32 s3, s3, 7
    s_add_u32 s3, s3, 22347776
    v_lshl_add_u32 v14, v3, 10, s3
    v_lshl_add_u32 v14, v7, 7, v14
    s_lshl_b32 s3, s37, 11
    v_lshl_add_u32 v6, v2, 8, s3
    v_lshlrev_b32 v4, 1, v4
    v_xor_b32 v2, v2, v4
    v_lshl_add_u32 v58, v2, 4, v6
    v_xor_b32 v59, 16, v58
    v_add_u32 v16, 98304, v58
    v_add_u32 v17, 98304, v59
    s_mov_b32 s46, 0xffff0000
    s_mov_b32 s48, 0x3b800000
    s_mov_b32 s49, 0x3b800000
    s_barrier
    buffer_load_dwordx4 v[50:53], v24, s[4:7], s45 offen offset:0
    buffer_load_dwordx4 v[54:57], v24, s[4:7], s45 offen offset:512
    s_sleep 4
    s_mov_b64 exec, 255
    buffer_load_dword v15, v14, s[12:15], 0 offen sc1
    s_mov_b64 exec, -1
    s_waitcnt vmcnt(3)
    s_barrier
    s_mov_b64 exec, 255
    s_waitcnt vmcnt(0)
    v_cmp_ne_u32 vcc, s66, v15
    s_cbranch_vccz P3_FP_END0
    s_mov_b32 s67, 0
P3_FP_SPIN0:
    s_mov_b64 exec, vcc
    s_sleep 4
    buffer_load_dword v15, v14, s[12:15], 0 offen sc1
    s_add_u32 s67, s67, 1
    s_cmp_gt_u32 s67, 20000
    s_waitcnt vmcnt(0)
    s_cbranch_scc1 P3_FP_END0
    v_cmp_ne_u32 vcc, s66, v15
    s_cbranch_vccnz P3_FP_SPIN0
P3_FP_END0:
    s_mov_b64 exec, -1
    s_add_u32 s3, s32, 1
    s_and_b32 s3, s3, 3
    s_lshl_b32 s3, s3, 21
    s_add_u32 s40, s43, s3
    s_add_u32 s41, s40, 16384
    buffer_load_dwordx4 v[26:29], v25, s[12:15], s40 offen sc1
    buffer_load_dwordx4 v[30:33], v25, s[12:15], s41 offen sc1
    s_add_u32 s3, s32, 2
    s_and_b32 s3, s3, 3
    s_lshl_b32 s3, s3, 21
    s_add_u32 s40, s43, s3
    s_add_u32 s41, s40, 16384
    buffer_load_dwordx4 v[34:37], v25, s[12:15], s40 offen sc1
    buffer_load_dwordx4 v[38:41], v25, s[12:15], s41 offen sc1
    s_add_u32 s3, s32, 3
    s_and_b32 s3, s3, 3
    s_lshl_b32 s3, s3, 21
    s_add_u32 s40, s43, s3
    s_add_u32 s41, s40, 16384
    buffer_load_dwordx4 v[42:45], v25, s[12:15], s40 offen sc1
    buffer_load_dwordx4 v[46:49], v25, s[12:15], s41 offen sc1
    ds_read_b128 v[60:63], v16 offset:0
    ds_read_b128 v[64:67], v17 offset:0
    ds_read_b128 v[68:71], v16 offset:8192
    ds_read_b128 v[72:75], v17 offset:8192
    v_lshlrev_b32 v76, 16, v50
    v_and_b32 v77, s46, v50
    v_lshlrev_b32 v78, 16, v51
    v_and_b32 v79, s46, v51
    v_lshlrev_b32 v80, 16, v52
    v_and_b32 v81, s46, v52
    v_lshlrev_b32 v82, 16, v53
    v_and_b32 v83, s46, v53
    s_waitcnt lgkmcnt(3)
    v_add_f32 v60, v60, v76
    v_add_f32 v61, v61, v77
    v_add_f32 v62, v62, v78
    v_add_f32 v63, v63, v79
    s_waitcnt lgkmcnt(2)
    v_add_f32 v64, v64, v80
    v_add_f32 v65, v65, v81
    v_add_f32 v66, v66, v82
    v_add_f32 v67, v67, v83
    v_lshlrev_b32 v76, 16, v54
    v_and_b32 v77, s46, v54
    v_lshlrev_b32 v78, 16, v55
    v_and_b32 v79, s46, v55
    v_lshlrev_b32 v80, 16, v56
    v_and_b32 v81, s46, v56
    v_lshlrev_b32 v82, 16, v57
    v_and_b32 v83, s46, v57
    s_waitcnt lgkmcnt(1)
    v_add_f32 v68, v68, v76
    v_add_f32 v69, v69, v77
    v_add_f32 v70, v70, v78
    v_add_f32 v71, v71, v79
    s_waitcnt lgkmcnt(0)
    v_add_f32 v72, v72, v80
    v_add_f32 v73, v73, v81
    v_add_f32 v74, v74, v82
    v_add_f32_e64 v75, v75, v83
    s_barrier
    ds_read_b128 v[84:87], v58 offset:0
    ds_read_b128 v[92:95], v58 offset:8192
    ds_read_b128 v[100:103], v58 offset:16384
    ds_read_b128 v[108:111], v58 offset:24576
    ds_read_b128 v[88:91], v59 offset:0
    ds_read_b128 v[96:99], v59 offset:8192
    ds_read_b128 v[104:107], v59 offset:16384
    ds_read_b128 v[112:115], v59 offset:24576
    s_waitcnt lgkmcnt(6)
    v_pk_add_f32 v[84:85], v[84:85], v[92:93]
    s_waitcnt lgkmcnt(4)
    v_pk_add_f32 v[100:101], v[100:101], v[108:109]
    v_pk_fma_f32 v[60:61], v[100:101], s[48:49], v[60:61]
    v_pk_fma_f32 v[68:69], v[100:101], s[48:49], v[68:69]
    v_pk_fma_f32 v[60:61], v[84:85], s[48:49], v[60:61]
    v_pk_fma_f32 v[68:69], v[84:85], s[48:49], v[68:69] neg_lo:[1,0,0] neg_hi:[1,0,0]
    v_pk_add_f32 v[86:87], v[86:87], v[94:95]
    v_pk_add_f32 v[102:103], v[102:103], v[110:111]
    v_pk_fma_f32 v[62:63], v[102:103], s[48:49], v[62:63]
    v_pk_fma_f32 v[70:71], v[102:103], s[48:49], v[70:71]
    v_pk_fma_f32 v[62:63], v[86:87], s[48:49], v[62:63]
    v_pk_fma_f32 v[70:71], v[86:87], s[48:49], v[70:71] neg_lo:[1,0,0] neg_hi:[1,0,0]
    s_waitcnt lgkmcnt(2)
    v_pk_add_f32 v[88:89], v[88:89], v[96:97]
    s_waitcnt lgkmcnt(0)
    v_pk_add_f32 v[104:105], v[104:105], v[112:113]
    v_pk_fma_f32 v[64:65], v[104:105], s[48:49], v[64:65]
    v_pk_fma_f32 v[72:73], v[104:105], s[48:49], v[72:73]
    v_pk_fma_f32 v[64:65], v[88:89], s[48:49], v[64:65]
    v_pk_fma_f32 v[72:73], v[88:89], s[48:49], v[72:73] neg_lo:[1,0,0] neg_hi:[1,0,0]
    v_pk_add_f32 v[90:91], v[90:91], v[98:99]
    v_pk_add_f32 v[106:107], v[106:107], v[114:115]
    v_pk_fma_f32 v[66:67], v[106:107], s[48:49], v[66:67]
    v_pk_fma_f32 v[74:75], v[106:107], s[48:49], v[74:75]
    v_pk_fma_f32 v[66:67], v[90:91], s[48:49], v[66:67]
    v_pk_fma_f32 v[74:75], v[90:91], s[48:49], v[74:75] neg_lo:[1,0,0] neg_hi:[1,0,0]
    s_waitcnt vmcnt(5)
    v_lshlrev_b32 v76, 16, v26
    v_and_b32 v77, s46, v26
    v_lshlrev_b32 v78, 16, v27
    v_and_b32 v79, s46, v27
    v_lshlrev_b32 v80, 16, v28
    v_and_b32 v81, s46, v28
    v_lshlrev_b32 v82, 16, v29
    v_and_b32 v83, s46, v29
    v_pk_add_f32 v[60:61], v[60:61], v[76:77]
    v_pk_add_f32 v[62:63], v[62:63], v[78:79]
    v_pk_add_f32 v[64:65], v[64:65], v[80:81]
    v_pk_add_f32 v[66:67], v[66:67], v[82:83]
    s_waitcnt vmcnt(4)
    v_lshlrev_b32 v76, 16, v30
    v_and_b32 v77, s46, v30
    v_lshlrev_b32 v78, 16, v31
    v_and_b32 v79, s46, v31
    v_lshlrev_b32 v80, 16, v32
    v_and_b32 v81, s46, v32
    v_lshlrev_b32 v82, 16, v33
    v_and_b32 v83, s46, v33
    v_pk_add_f32 v[68:69], v[68:69], v[76:77]
    v_pk_add_f32 v[70:71], v[70:71], v[78:79]
    v_pk_add_f32 v[72:73], v[72:73], v[80:81]
    v_pk_add_f32 v[74:75], v[74:75], v[82:83]
    s_waitcnt vmcnt(3)
    v_lshlrev_b32 v76, 16, v34
    v_and_b32 v77, s46, v34
    v_lshlrev_b32 v78, 16, v35
    v_and_b32 v79, s46, v35
    v_lshlrev_b32 v80, 16, v36
    v_and_b32 v81, s46, v36
    v_lshlrev_b32 v82, 16, v37
    v_and_b32 v83, s46, v37
    v_pk_add_f32 v[60:61], v[60:61], v[76:77]
    v_pk_add_f32 v[62:63], v[62:63], v[78:79]
    v_pk_add_f32 v[64:65], v[64:65], v[80:81]
    v_pk_add_f32 v[66:67], v[66:67], v[82:83]
    s_waitcnt vmcnt(2)
    v_lshlrev_b32 v76, 16, v38
    v_and_b32 v77, s46, v38
    v_lshlrev_b32 v78, 16, v39
    v_and_b32 v79, s46, v39
    v_lshlrev_b32 v80, 16, v40
    v_and_b32 v81, s46, v40
    v_lshlrev_b32 v82, 16, v41
    v_and_b32 v83, s46, v41
    v_pk_add_f32 v[68:69], v[68:69], v[76:77]
    v_pk_add_f32 v[70:71], v[70:71], v[78:79]
    v_pk_add_f32 v[72:73], v[72:73], v[80:81]
    v_pk_add_f32 v[74:75], v[74:75], v[82:83]
    s_waitcnt vmcnt(1)
    v_lshlrev_b32 v76, 16, v42
    v_and_b32 v77, s46, v42
    v_lshlrev_b32 v78, 16, v43
    v_and_b32 v79, s46, v43
    v_lshlrev_b32 v80, 16, v44
    v_and_b32 v81, s46, v44
    v_lshlrev_b32 v82, 16, v45
    v_and_b32_e64 v83, s46, v45
    v_pk_add_f32 v[60:61], v[60:61], v[76:77]
    v_pk_add_f32 v[62:63], v[62:63], v[78:79]
    v_pk_add_f32 v[64:65], v[64:65], v[80:81]
    v_pk_add_f32 v[66:67], v[66:67], v[82:83]
    v_cvt_pk_bf16_f32 v116, v60, v61
    v_cvt_pk_bf16_f32 v117, v62, v63
    v_cvt_pk_bf16_f32 v118, v64, v65
    v_cvt_pk_bf16_f32 v119, v66, v67
    buffer_store_dwordx4 v[116:119], v24, s[16:19], s45 offen offset:0 sc1
    s_waitcnt vmcnt(1)
    v_lshlrev_b32 v76, 16, v46
    v_and_b32 v77, s46, v46
    v_lshlrev_b32 v78, 16, v47
    v_and_b32 v79, s46, v47
    v_lshlrev_b32 v80, 16, v48
    v_and_b32 v81, s46, v48
    v_lshlrev_b32 v82, 16, v49
    v_and_b32_e64 v83, s46, v49
    v_pk_add_f32 v[68:69], v[68:69], v[76:77]
    v_pk_add_f32 v[70:71], v[70:71], v[78:79]
    v_pk_add_f32 v[72:73], v[72:73], v[80:81]
    v_pk_add_f32 v[74:75], v[74:75], v[82:83]
    v_cvt_pk_bf16_f32 v120, v68, v69
    v_cvt_pk_bf16_f32 v121, v70, v71
    v_cvt_pk_bf16_f32 v122, v72, v73
    v_cvt_pk_bf16_f32 v123, v74, v75
    buffer_store_dwordx4 v[120:123], v24, s[16:19], s45 offen offset:512 sc1
    s_or_b32 s3, s2, s37
    s_cmp_lg_u32 s3, 0
    s_cbranch_scc1 P3_NOEPOCH
    v_mov_b32 v2, 22315008
    v_mov_b32 v4, s66
    s_mov_b64 exec, 1
    buffer_store_dword v4, v2, s[12:15], 0 offen sc1
    s_mov_b64 exec, -1
P3_NOEPOCH:
    s_endpgm
K1_END:
    s_endpgm
code_end:
.section .rodata,"a"
.p2align 6
.amdhsa_kernel parallel_sum__spectral_gfnet__dense_activation_silu__prompt_kernel
  .amdhsa_next_free_vgpr 256
  .amdhsa_next_free_sgpr 102
  .amdhsa_accum_offset 256
  .amdhsa_group_segment_fixed_size 0
  .amdhsa_kernarg_size 72
  .amdhsa_user_sgpr_count 2
  .amdhsa_user_sgpr_kernarg_segment_ptr 1
  .amdhsa_system_sgpr_workgroup_id_x 1
  .amdhsa_float_denorm_mode_32 3
.end_amdhsa_kernel
.p2align 8
.type dft_table,@object
dft_table:
.altmacro
.macro E8 a,b,c,d,e,f,g,h
.short C\a,C\b,C\c,C\d,C\e,C\f,C\g,C\h
.endm
.set C0,0x3f80
.set C1,0x3f80
.set C2,0x3f80
.set C3,0x3f80
.set C4,0x3f80
.set C5,0x3f80
.set C6,0x3f7f
.set C7,0x3f7f
.set C8,0x3f7f
.set C9,0x3f7e
.set C10,0x3f7e
.set C11,0x3f7e
.set C12,0x3f7d
.set C13,0x3f7d
.set C14,0x3f7c
.set C15,0x3f7c
.set C16,0x3f7b
.set C17,0x3f7a
.set C18,0x3f7a
.set C19,0x3f79
.set C20,0x3f78
.set C21,0x3f78
.set C22,0x3f77
.set C23,0x3f76
.set C24,0x3f75
.set C25,0x3f74
.set C26,0x3f73
.set C27,0x3f72
.set C28,0x3f71
.set C29,0x3f70
.set C30,0x3f6f
.set C31,0x3f6e
.set C32,0x3f6d
.set C33,0x3f6b
.set C34,0x3f6a
.set C35,0x3f69
.set C36,0x3f67
.set C37,0x3f66
.set C38,0x3f65
.set C39,0x3f63
.set C40,0x3f62
.set C41,0x3f60
.set C42,0x3f5f
.set C43,0x3f5d
.set C44,0x3f5c
.set C45,0x3f5a
.set C46,0x3f58
.set C47,0x3f57
.set C48,0x3f55
.set C49,0x3f53
.set C50,0x3f51
.set C51,0x3f4f
.set C52,0x3f4e
.set C53,0x3f4c
.set C54,0x3f4a
.set C55,0x3f48
.set C56,0x3f46
.set C57,0x3f44
.set C58,0x3f42
.set C59,0x3f40
.set C60,0x3f3e
.set C61,0x3f3c
.set C62,0x3f39
.set C63,0x3f37
.set C64,0x3f35
.set C65,0x3f33
.set C66,0x3f31
.set C67,0x3f2e
.set C68,0x3f2c
.set C69,0x3f2a
.set C70,0x3f27
.set C71,0x3f25
.set C72,0x3f22
.set C73,0x3f20
.set C74,0x3f1d
.set C75,0x3f1b
.set C76,0x3f18
.set C77,0x3f16
.set C78,0x3f13
.set C79,0x3f11
.set C80,0x3f0e
.set C81,0x3f0c
.set C82,0x3f09
.set C83,0x3f06
.set C84,0x3f04
.set C85,0x3f01
.set C86,0x3efc
.set C87,0x3ef7
.set C88,0x3ef1
.set C89,0x3eec
.set C90,0x3ee6
.set C91,0x3ee1
.set C92,0x3edb
.set C93,0x3ed5
.set C94,0x3ecf
.set C95,0x3eca
.set C96,0x3ec4
.set C97,0x3ebe
.set C98,0x3eb8
.set C99,0x3eb2
.set C100,0x3eac
.set C101,0x3ea7
.set C102,0x3ea1
.set C103,0x3e9b
.set C104,0x3e95
.set C105,0x3e8f
.set C106,0x3e89
.set C107,0x3e82
.set C108,0x3e79
.set C109,0x3e6d
.set C110,0x3e60
.set C111,0x3e54
.set C112,0x3e48
.set C113,0x3e3b
.set C114,0x3e2f
.set C115,0x3e23
.set C116,0x3e16
.set C117,0x3e0a
.set C118,0x3dfb
.set C119,0x3de2
.set C120,0x3dc9
.set C121,0x3db0
.set C122,0x3d97
.set C123,0x3d7b
.set C124,0x3d49
.set C125,0x3d17
.set C126,0x3cc9
.set C127,0x3c49
.set C128,0x0
.set C129,0xbc49
.set C130,0xbcc9
.set C131,0xbd17
.set C132,0xbd49
.set C133,0xbd7b
.set C134,0xbd97
.set C135,0xbdb0
.set C136,0xbdc9
.set C137,0xbde2
.set C138,0xbdfb
.set C139,0xbe0a
.set C140,0xbe16
.set C141,0xbe23
.set C142,0xbe2f
.set C143,0xbe3b
.set C144,0xbe48
.set C145,0xbe54
.set C146,0xbe60
.set C147,0xbe6d
.set C148,0xbe79
.set C149,0xbe82
.set C150,0xbe89
.set C151,0xbe8f
.set C152,0xbe95
.set C153,0xbe9b
.set C154,0xbea1
.set C155,0xbea7
.set C156,0xbeac
.set C157,0xbeb2
.set C158,0xbeb8
.set C159,0xbebe
.set C160,0xbec4
.set C161,0xbeca
.set C162,0xbecf
.set C163,0xbed5
.set C164,0xbedb
.set C165,0xbee1
.set C166,0xbee6
.set C167,0xbeec
.set C168,0xbef1
.set C169,0xbef7
.set C170,0xbefc
.set C171,0xbf01
.set C172,0xbf04
.set C173,0xbf06
.set C174,0xbf09
.set C175,0xbf0c
.set C176,0xbf0e
.set C177,0xbf11
.set C178,0xbf13
.set C179,0xbf16
.set C180,0xbf18
.set C181,0xbf1b
.set C182,0xbf1d
.set C183,0xbf20
.set C184,0xbf22
.set C185,0xbf25
.set C186,0xbf27
.set C187,0xbf2a
.set C188,0xbf2c
.set C189,0xbf2e
.set C190,0xbf31
.set C191,0xbf33
.set C192,0xbf35
.set C193,0xbf37
.set C194,0xbf39
.set C195,0xbf3c
.set C196,0xbf3e
.set C197,0xbf40
.set C198,0xbf42
.set C199,0xbf44
.set C200,0xbf46
.set C201,0xbf48
.set C202,0xbf4a
.set C203,0xbf4c
.set C204,0xbf4e
.set C205,0xbf4f
.set C206,0xbf51
.set C207,0xbf53
.set C208,0xbf55
.set C209,0xbf57
.set C210,0xbf58
.set C211,0xbf5a
.set C212,0xbf5c
.set C213,0xbf5d
.set C214,0xbf5f
.set C215,0xbf60
.set C216,0xbf62
.set C217,0xbf63
.set C218,0xbf65
.set C219,0xbf66
.set C220,0xbf67
.set C221,0xbf69
.set C222,0xbf6a
.set C223,0xbf6b
.set C224,0xbf6d
.set C225,0xbf6e
.set C226,0xbf6f
.set C227,0xbf70
.set C228,0xbf71
.set C229,0xbf72
.set C230,0xbf73
.set C231,0xbf74
.set C232,0xbf75
.set C233,0xbf76
.set C234,0xbf77
.set C235,0xbf78
.set C236,0xbf78
.set C237,0xbf79
.set C238,0xbf7a
.set C239,0xbf7a
.set C240,0xbf7b
.set C241,0xbf7c
.set C242,0xbf7c
.set C243,0xbf7d
.set C244,0xbf7d
.set C245,0xbf7e
.set C246,0xbf7e
.set C247,0xbf7e
.set C248,0xbf7f
.set C249,0xbf7f
.set C250,0xbf7f
.set C251,0xbf80
.set C252,0xbf80
.set C253,0xbf80
.set C254,0xbf80
.set C255,0xbf80
.set C256,0xbf80
.set C257,0xbf80
.set C258,0xbf80
.set C259,0xbf80
.set C260,0xbf80
.set C261,0xbf80
.set C262,0xbf7f
.set C263,0xbf7f
.set C264,0xbf7f
.set C265,0xbf7e
.set C266,0xbf7e
.set C267,0xbf7e
.set C268,0xbf7d
.set C269,0xbf7d
.set C270,0xbf7c
.set C271,0xbf7c
.set C272,0xbf7b
.set C273,0xbf7a
.set C274,0xbf7a
.set C275,0xbf79
.set C276,0xbf78
.set C277,0xbf78
.set C278,0xbf77
.set C279,0xbf76
.set C280,0xbf75
.set C281,0xbf74
.set C282,0xbf73
.set C283,0xbf72
.set C284,0xbf71
.set C285,0xbf70
.set C286,0xbf6f
.set C287,0xbf6e
.set C288,0xbf6d
.set C289,0xbf6b
.set C290,0xbf6a
.set C291,0xbf69
.set C292,0xbf67
.set C293,0xbf66
.set C294,0xbf65
.set C295,0xbf63
.set C296,0xbf62
.set C297,0xbf60
.set C298,0xbf5f
.set C299,0xbf5d
.set C300,0xbf5c
.set C301,0xbf5a
.set C302,0xbf58
.set C303,0xbf57
.set C304,0xbf55
.set C305,0xbf53
.set C306,0xbf51
.set C307,0xbf4f
.set C308,0xbf4e
.set C309,0xbf4c
.set C310,0xbf4a
.set C311,0xbf48
.set C312,0xbf46
.set C313,0xbf44
.set C314,0xbf42
.set C315,0xbf40
.set C316,0xbf3e
.set C317,0xbf3c
.set C318,0xbf39
.set C319,0xbf37
.set C320,0xbf35
.set C321,0xbf33
.set C322,0xbf31
.set C323,0xbf2e
.set C324,0xbf2c
.set C325,0xbf2a
.set C326,0xbf27
.set C327,0xbf25
.set C328,0xbf22
.set C329,0xbf20
.set C330,0xbf1d
.set C331,0xbf1b
.set C332,0xbf18
.set C333,0xbf16
.set C334,0xbf13
.set C335,0xbf11
.set C336,0xbf0e
.set C337,0xbf0c
.set C338,0xbf09
.set C339,0xbf06
.set C340,0xbf04
.set C341,0xbf01
.set C342,0xbefc
.set C343,0xbef7
.set C344,0xbef1
.set C345,0xbeec
.set C346,0xbee6
.set C347,0xbee1
.set C348,0xbedb
.set C349,0xbed5
.set C350,0xbecf
.set C351,0xbeca
.set C352,0xbec4
.set C353,0xbebe
.set C354,0xbeb8
.set C355,0xbeb2
.set C356,0xbeac
.set C357,0xbea7
.set C358,0xbea1
.set C359,0xbe9b
.set C360,0xbe95
.set C361,0xbe8f
.set C362,0xbe89
.set C363,0xbe82
.set C364,0xbe79
.set C365,0xbe6d
.set C366,0xbe60
.set C367,0xbe54
.set C368,0xbe48
.set C369,0xbe3b
.set C370,0xbe2f
.set C371,0xbe23
.set C372,0xbe16
.set C373,0xbe0a
.set C374,0xbdfb
.set C375,0xbde2
.set C376,0xbdc9
.set C377,0xbdb0
.set C378,0xbd97
.set C379,0xbd7b
.set C380,0xbd49
.set C381,0xbd17
.set C382,0xbcc9
.set C383,0xbc49
.set C384,0x0
.set C385,0x3c49
.set C386,0x3cc9
.set C387,0x3d17
.set C388,0x3d49
.set C389,0x3d7b
.set C390,0x3d97
.set C391,0x3db0
.set C392,0x3dc9
.set C393,0x3de2
.set C394,0x3dfb
.set C395,0x3e0a
.set C396,0x3e16
.set C397,0x3e23
.set C398,0x3e2f
.set C399,0x3e3b
.set C400,0x3e48
.set C401,0x3e54
.set C402,0x3e60
.set C403,0x3e6d
.set C404,0x3e79
.set C405,0x3e82
.set C406,0x3e89
.set C407,0x3e8f
.set C408,0x3e95
.set C409,0x3e9b
.set C410,0x3ea1
.set C411,0x3ea7
.set C412,0x3eac
.set C413,0x3eb2
.set C414,0x3eb8
.set C415,0x3ebe
.set C416,0x3ec4
.set C417,0x3eca
.set C418,0x3ecf
.set C419,0x3ed5
.set C420,0x3edb
.set C421,0x3ee1
.set C422,0x3ee6
.set C423,0x3eec
.set C424,0x3ef1
.set C425,0x3ef7
.set C426,0x3efc
.set C427,0x3f01
.set C428,0x3f04
.set C429,0x3f06
.set C430,0x3f09
.set C431,0x3f0c
.set C432,0x3f0e
.set C433,0x3f11
.set C434,0x3f13
.set C435,0x3f16
.set C436,0x3f18
.set C437,0x3f1b
.set C438,0x3f1d
.set C439,0x3f20
.set C440,0x3f22
.set C441,0x3f25
.set C442,0x3f27
.set C443,0x3f2a
.set C444,0x3f2c
.set C445,0x3f2e
.set C446,0x3f31
.set C447,0x3f33
.set C448,0x3f35
.set C449,0x3f37
.set C450,0x3f39
.set C451,0x3f3c
.set C452,0x3f3e
.set C453,0x3f40
.set C454,0x3f42
.set C455,0x3f44
.set C456,0x3f46
.set C457,0x3f48
.set C458,0x3f4a
.set C459,0x3f4c
.set C460,0x3f4e
.set C461,0x3f4f
.set C462,0x3f51
.set C463,0x3f53
.set C464,0x3f55
.set C465,0x3f57
.set C466,0x3f58
.set C467,0x3f5a
.set C468,0x3f5c
.set C469,0x3f5d
.set C470,0x3f5f
.set C471,0x3f60
.set C472,0x3f62
.set C473,0x3f63
.set C474,0x3f65
.set C475,0x3f66
.set C476,0x3f67
.set C477,0x3f69
.set C478,0x3f6a
.set C479,0x3f6b
.set C480,0x3f6d
.set C481,0x3f6e
.set C482,0x3f6f
.set C483,0x3f70
.set C484,0x3f71
.set C485,0x3f72
.set C486,0x3f73
.set C487,0x3f74
.set C488,0x3f75
.set C489,0x3f76
.set C490,0x3f77
.set C491,0x3f78
.set C492,0x3f78
.set C493,0x3f79
.set C494,0x3f7a
.set C495,0x3f7a
.set C496,0x3f7b
.set C497,0x3f7c
.set C498,0x3f7c
.set C499,0x3f7d
.set C500,0x3f7d
.set C501,0x3f7e
.set C502,0x3f7e
.set C503,0x3f7e
.set C504,0x3f7f
.set C505,0x3f7f
.set C506,0x3f7f
.set C507,0x3f80
.set C508,0x3f80
.set C509,0x3f80
.set C510,0x3f80
.set C511,0x3f80
.set blk,0
.rept 128
.set ln,0
.rept 64
.set cl,(blk>>1)&3
.set kap,1+32*(blk>>6)+(ln&31)
.set ph,128*(blk&1)+(64*((blk>>3)&7)+32*(ln>>5)+cl)*kap
E8 %(ph&511),%((ph+4*kap)&511),%((ph+8*kap)&511),%((ph+12*kap)&511),%((ph+16*kap)&511),%((ph+20*kap)&511),%((ph+24*kap)&511),%((ph+28*kap)&511)
.set ln,ln+1
.endr
.set blk,blk+1
.endr
.noaltmacro
.size dft_table,131072
```
